```python
import torch

def _softmax(x, axis=-1):
    return torch.softmax(x, dim=axis)
def _gelu(x):
    return torch.nn.functional.gelu(x, approximate="tanh")
def _silu(x):
    return torch.nn.functional.silu(x)
def _sigmoid(x):
    return torch.sigmoid(x)
def _layernorm(x, axis=-1, eps=1e-5):
    m = x.mean(dim=axis, keepdim=True)
    v = x.var(dim=axis, keepdim=True, unbiased=False)
    return (x - m) / torch.sqrt(v + eps)
def _scatter_add(tgt, idx, src, axis=0):
    return tgt.clone().index_add_(axis, idx, src)
def _segment_sum(src, seg, n):
    out = torch.zeros((n,) + src.shape[1:], dtype=src.dtype)
    return out.index_add_(0, seg, src)
def _pad(x, pw):
    flat = tuple(v for pair in reversed(pw) for v in pair)
    return torch.nn.functional.pad(x, flat)

kernel_name = 'gated_mix__ssm_conv_h3__glu_gated_geglu__prompt'

def setup_inputs():

    _w = (lambda a: (lambda t: t.to(torch.bfloat16) if t.is_floating_point() else t)(torch.as_tensor(a)))
    def _A_setup():
        B, S, D = 1, 2048, 512
        ks = 4
        return {
            "q": _w((lambda *s: torch.randn(*s, dtype=torch.bfloat16) * 0.05)(B, S, D)),
            "k": _w((lambda *s: torch.randn(*s, dtype=torch.bfloat16) * 0.05)(B, S, D)),
            "v": _w((lambda *s: torch.randn(*s, dtype=torch.bfloat16) * 0.05)(B, S, D)),
            "shift_k": _w((lambda *s: torch.randn(*s, dtype=torch.bfloat16) * 0.05)(D, ks) * 0.5),
            "ssm_k": _w((lambda *s: torch.randn(*s, dtype=torch.bfloat16) * 0.05)(D, S) * (1.0 / S ** 0.5)),
            "ssm_D": _w((lambda *s: torch.randn(*s, dtype=torch.bfloat16) * 0.05)(D)),
        }
    _A_in = _A_setup()

    def _B_setup():
        B, S, Dm, Df = 1, 2048, 512, 1792
        return {
            "x": _w((lambda *s: torch.randn(*s, dtype=torch.bfloat16) * 0.05)(B, S, Dm)),
            "w_gate": _w((lambda *s: torch.randn(*s, dtype=torch.bfloat16) * 0.1)(Dm, Df) * (Dm ** -0.5)),
            "w_up": _w((lambda *s: torch.randn(*s, dtype=torch.bfloat16) * 0.1)(Dm, Df) * (Dm ** -0.5)),
            "w_down": _w((lambda *s: torch.randn(*s, dtype=torch.bfloat16) * 0.1)(Df, Dm) * (Df ** -0.5)),
        }
    _B_in = _B_setup()

    return {
        "A_q": _A_in["q"],
        "A_k": _A_in["k"],
        "A_v": _A_in["v"],
        "A_shift_k": _A_in["shift_k"],
        "A_ssm_k": _A_in["ssm_k"],
        "A_ssm_D": _A_in["ssm_D"],
        "B_x": _B_in["x"],
        "B_w_gate": _B_in["w_gate"],
        "B_w_up": _B_in["w_up"],
        "B_w_down": _B_in["w_down"],
        "gate_w": _w((lambda *s: torch.randn(*s, dtype=torch.bfloat16) * 0.05)(512) * 16.0),
    }

def reference(A_q, A_k, A_v, A_shift_k, A_ssm_k, A_ssm_D, B_x, B_w_gate, B_w_up, B_w_down, gate_w):
    def _A_ref(q, k, v, shift_k, ssm_k, ssm_D):
        B, S, D = q.shape
        ks = shift_k.shape[-1]
        k_pad = _pad(k, ((0, 0), (ks - 1, 0), (0, 0)))
        k_shift = torch.zeros_like(k)
        for t in range(ks):
            k_shift = k_shift + k_pad[:, t:t + S, :] * shift_k[:, ks - 1 - t][None, None, :]
        kv = k_shift * v
        L = 2 * S
        kv_pad = _pad(kv, ((0, 0), (0, S), (0, 0)))
        kf_pad = _pad(ssm_k, ((0, 0), (0, S)))
        kv_f = (lambda x, axes=(-2,-1): torch.fft.rfft2(x.float(), dim=axes))(kv_pad[:, None, :, :], axes=(1, 2))
        kf_f = (lambda x, axes=(-2,-1): torch.fft.rfft2(x.float(), dim=axes))(kf_pad[:, None, :], axes=(1, 2))
        kf_f = (lambda x, *d: x.permute(*d))(kf_f, 1, 2, 0)
        y_f = kv_f * kf_f[None, :, :, :]
        y = (lambda x, s, axes=(-2,-1): torch.fft.irfft2(x, s=s, dim=axes).to(torch.bfloat16))(y_f, (1, L), axes=(1, 2))[:, 0, :S, :]
        y = y + kv * ssm_D[None, None, :]
        return q * y

    def _B_ref(x, w_gate, w_up, w_down):
        g = torch.einsum("bsd,df->bsf", x, w_gate)
        u = torch.einsum("bsd,df->bsf", x, w_up)
        h = _gelu(g) * u
        return torch.einsum("bsf,fd->bsd", h, w_down)

    x = A_q
    g = _sigmoid((x * gate_w).sum(-1, keepdims=True))
    a = _A_ref(x, A_k, A_v, A_shift_k, A_ssm_k, A_ssm_D)
    b = _B_ref(x, B_w_gate, B_w_up, B_w_down)
    return g * a + (1 - g) * b
```

```asm
; @launch grid=(256,1,1) block=(512,1,1) lds=163840
.amdgcn_target "amdgcn-amd-amdhsa--gfx950"
.text
.globl gated_mix__ssm_conv_h3__glu_gated_geglu__prompt_kernel
.p2align 8
.type gated_mix__ssm_conv_h3__glu_gated_geglu__prompt_kernel,@function
gated_mix__ssm_conv_h3__glu_gated_geglu__prompt_kernel:
  s_cmp_ge_u32 s2, 256
  s_cbranch_scc1 L_END
  s_load_dwordx16 s[64:79], s[0:1], 0
  s_load_dwordx8 s[80:87], s[0:1], 64
  s_load_dwordx4 s[88:91], s[0:1], 96
  v_and_b32 v1, 63, v0
  v_lshrrev_b32 v2, 6, v0
  s_nop 0
  v_readfirstlane_b32 s60, v2
  s_waitcnt lgkmcnt(0)
  s_load_dword s61, s[90:91], 12288
  s_cmp_eq_u32 s60, 1
  s_cbranch_scc0 CPF_1
  s_getpc_b64 s[92:93]
L_PC:
  s_sub_u32 s92, s92, L_PC-gated_mix__ssm_conv_h3__glu_gated_geglu__prompt_kernel
  s_subb_u32 s93, s93, 0
  s_lshr_b32 s94, s2, 3
  s_lshl_b32 s94, s94, 3
  v_and_b32 v2, 7, v1
  v_add_u32 v2, s94, v2
  v_lshlrev_b32 v2, 7, v2
  v_min_u32 v2, L_END-gated_mix__ssm_conv_h3__glu_gated_geglu__prompt_kernel, v2
  global_load_dword v255, v2, s[92:93]
CPF_1:
  s_cmp_eq_u32 s60, 2
  s_cbranch_scc0 TLB_2
  v_mov_b32 v2, s64
  v_mov_b32 v3, s65
  v_writelane_b32 v2, s66, 1
  v_writelane_b32 v3, s67, 1
  v_writelane_b32 v2, s68, 2
  v_writelane_b32 v3, s69, 2
  v_writelane_b32 v2, s70, 3
  v_writelane_b32 v3, s71, 3
  v_writelane_b32 v2, s72, 4
  v_writelane_b32 v3, s73, 4
  v_writelane_b32 v2, s74, 5
  v_writelane_b32 v3, s75, 5
  v_writelane_b32 v2, s78, 6
  v_writelane_b32 v3, s79, 6
  v_writelane_b32 v2, s80, 7
  v_writelane_b32 v3, s81, 7
  v_writelane_b32 v2, s82, 8
  v_writelane_b32 v3, s83, 8
  v_writelane_b32 v2, s84, 9
  v_writelane_b32 v3, s85, 9
  v_writelane_b32 v2, s86, 10
  v_writelane_b32 v3, s87, 10
  s_add_u32 s92, s90, 32768
  s_addc_u32 s93, s91, 0
  v_writelane_b32 v2, s92, 11
  v_writelane_b32 v3, s93, 11
  s_add_u32 s92, s90, 2129920
  s_addc_u32 s93, s91, 0
  v_writelane_b32 v2, s92, 12
  v_writelane_b32 v3, s93, 12
  s_add_u32 s92, s90, 4227072
  s_addc_u32 s93, s91, 0
  v_writelane_b32 v2, s92, 13
  v_writelane_b32 v3, s93, 13
  s_add_u32 s92, s90, 6324224
  s_addc_u32 s93, s91, 0
  v_writelane_b32 v2, s92, 14
  v_writelane_b32 v3, s93, 14
  s_add_u32 s92, s90, 8421376
  s_addc_u32 s93, s91, 0
  v_writelane_b32 v2, s92, 15
  v_writelane_b32 v3, s93, 15
  s_add_u32 s92, s90, 10518528
  s_addc_u32 s93, s91, 0
  v_writelane_b32 v2, s92, 16
  v_writelane_b32 v3, s93, 16
  global_load_dword v255, v[2:3], off
TLB_2:
  s_mov_b32 s4, s90
  s_and_b32 s5, s91, 0xffff
  s_mov_b32 s6, 11599872
  s_mov_b32 s7, 0x20000
  s_mov_b32 s8, s64
  s_and_b32 s9, s65, 0xffff
  s_mov_b32 s10, 2097152
  s_mov_b32 s11, 0x20000
  s_mov_b32 s12, s78
  s_and_b32 s13, s79, 0xffff
  s_mov_b32 s14, 1835008
  s_mov_b32 s15, 0x20000
  s_mov_b32 s16, s80
  s_and_b32 s17, s81, 0xffff
  s_mov_b32 s18, 1835008
  s_mov_b32 s19, 0x20000
  s_mov_b32 s20, s82
  s_and_b32 s21, s83, 0xffff
  s_mov_b32 s22, 1835008
  s_mov_b32 s23, 0x20000
  s_mov_b32 s24, s64
  s_and_b32 s25, s65, 0xffff
  s_mov_b32 s26, 2097152
  s_mov_b32 s27, 0x20000
  s_mov_b32 s28, s86
  s_and_b32 s29, s87, 0xffff
  s_mov_b32 s30, 2097152
  s_mov_b32 s31, 0x20000
  s_mov_b32 s32, s66
  s_and_b32 s33, s67, 0xffff
  s_mov_b32 s34, 2097152
  s_mov_b32 s35, 0x20000
  s_mov_b32 s36, s68
  s_and_b32 s37, s69, 0xffff
  s_mov_b32 s38, 2097152
  s_mov_b32 s39, 0x20000
  s_mov_b32 s40, s70
  s_and_b32 s41, s71, 0xffff
  s_mov_b32 s42, 4096
  s_mov_b32 s43, 0x20000
  s_mov_b32 s44, s84
  s_and_b32 s45, s85, 0xffff
  s_mov_b32 s46, 1024
  s_mov_b32 s47, 0x20000
  s_mov_b32 s48, s74
  s_and_b32 s49, s75, 0xffff
  s_mov_b32 s50, 1024
  s_mov_b32 s51, 0x20000
  s_mov_b32 s52, s72
  s_and_b32 s53, s73, 0xffff
  s_mov_b32 s54, 2097152
  s_mov_b32 s55, 0x20000
  s_and_b32 s62, s2, 7
  s_lshr_b32 s63, s2, 3
  s_lshr_b32 s64, s62, 2
  s_lshl_b32 s64, s64, 3
  s_lshr_b32 s66, s63, 2
  s_add_u32 s64, s64, s66
  s_and_b32 s65, s62, 3
  s_lshl_b32 s65, s65, 2
  s_and_b32 s66, s63, 3
  s_add_u32 s65, s65, s66
  s_cmp_ge_u32 s60, 4
  s_cbranch_scc1 L_GB
  s_lshr_b32 s66, s62, 2
  s_lshl_b32 s66, s66, 10
  s_lshl_b32 s67, s63, 5
  s_add_u32 s66, s66, s67
  v_add_u32 v2, s66, v1
  v_lshlrev_b32 v2, 10, v2
  s_mul_i32 s66, s63, 28
  v_subrev_u32 v3, 32, v1
  v_min_u32 v3, 27, v3
  v_add_u32 v3, s66, v3
  v_cmp_le_u32 vcc, 448, v3
  v_subrev_u32 v4, 448, v3
  s_mov_b64 s[68:69], vcc
  s_nop 0
  v_cndmask_b32 v3, v3, v4, s[68:69]
  v_mul_u32_u24 v4, 9363, v3
  v_lshrrev_b32 v4, 16, v4
  v_mul_u32_u24 v5, 7, v4
  v_sub_u32 v5, v3, v5
  v_mul_u32_u24 v4, 3584, v4
  v_lshl_add_u32 v4, v5, 7, v4
  s_and_b32 s66, s62, 3
  s_mul_i32 s66, s66, 896
  v_add_u32 v4, s66, v4
  v_mov_b32 v5, s12
  v_mov_b32 v6, s13
  v_mov_b32 v7, s16
  v_mov_b32 v8, s17
  v_cndmask_b32 v5, v5, v7, s[68:69]
  v_cndmask_b32 v6, v6, v8, s[68:69]
  v_mov_b32 v7, s8
  v_mov_b32 v8, s9
  v_mov_b32 v12, 229376
  v_mov_b32 v3, 128
  v_cmp_gt_u32 vcc, 32, v1
  s_nop 1
  v_cndmask_b32 v4, v4, v2, vcc
  v_cndmask_b32 v5, v5, v7, vcc
  v_cndmask_b32 v6, v6, v8, vcc
  v_cndmask_b32 v12, v12, v3, vcc
  v_add_co_u32 v10, vcc, v5, v4
  s_nop 1
  v_addc_co_u32 v11, vcc, 0, v6, vcc
  s_cmp_eq_u32 s60, 0
  s_cbranch_scc0 Q0_3
  s_mov_b32 s71, 0
  v_mad_u64_u32 v[14:15], s[68:69], v12, s71, v[10:11]
  s_nop 0
  global_load_dword v254, v[14:15], off
  s_mov_b32 s71, 1
  v_mad_u64_u32 v[14:15], s[68:69], v12, s71, v[10:11]
  s_nop 0
  global_load_dword v254, v[14:15], off
Q0_3:
  v_lshrrev_b32 v2, 3, v1
  s_lshl_b32 s78, s60, 12
  v_add_u32 v3, 0, v2
  v_lshrrev_b32 v4, 1, v3
  v_xor_b32 v4, v4, v1
  v_and_b32 v4, 7, v4
  v_lshlrev_b32 v4, 4, v4
  v_lshl_add_u32 v16, v2, 10, v4
  s_lshl_b32 s66, s64, 17
  s_lshl_b32 s67, s60, 15
  s_add_u32 s66, s66, s67
  v_add_u32 v16, s66, v16
  v_add_u32 v3, 8, v2
  v_lshrrev_b32 v4, 1, v3
  v_xor_b32 v4, v4, v1
  v_and_b32 v4, 7, v4
  v_lshlrev_b32 v4, 4, v4
  v_lshl_add_u32 v17, v2, 10, v4
  s_lshl_b32 s66, s64, 17
  s_lshl_b32 s67, s60, 15
  s_add_u32 s66, s66, s67
  v_add_u32 v17, s66, v17
  s_lshr_b32 s72, s60, 1
  s_and_b32 s73, s60, 1
  s_lshl_b32 s66, s72, 1
  s_add_u32 s74, s66, s73
  s_lshl_b32 s66, s74, 12
  v_and_b32 v2, 31, v1
  v_lshrrev_b32 v3, 1, v2
  v_and_b32 v3, 7, v3
  v_lshrrev_b32 v4, 5, v1
  v_lshlrev_b32 v2, 7, v2
  v_add_u32 v2, s66, v2
  v_add_u32 v5, 0, v4
  v_xor_b32 v5, v5, v3
  v_lshl_add_u32 v6, v5, 4, v2
  v_xor_b32 v7, 0x1000, v6
  v_add_u32 v200, 0, v6
  v_add_u32 v204, 0, v7
  v_add_u32 v208, 45184, v6
  v_add_u32 v212, 45184, v7
  v_add_u32 v216, 90368, v6
  v_add_u32 v220, 90368, v7
  v_add_u32 v5, 2, v4
  v_xor_b32 v5, v5, v3
  v_lshl_add_u32 v6, v5, 4, v2
  v_xor_b32 v7, 0x1000, v6
  v_add_u32 v201, 0, v6
  v_add_u32 v205, 0, v7
  v_add_u32 v209, 45184, v6
  v_add_u32 v213, 45184, v7
  v_add_u32 v217, 90368, v6
  v_add_u32 v221, 90368, v7
  v_add_u32 v5, 4, v4
  v_xor_b32 v5, v5, v3
  v_lshl_add_u32 v6, v5, 4, v2
  v_xor_b32 v7, 0x1000, v6
  v_add_u32 v202, 0, v6
  v_add_u32 v206, 0, v7
  v_add_u32 v210, 45184, v6
  v_add_u32 v214, 45184, v7
  v_add_u32 v218, 90368, v6
  v_add_u32 v222, 90368, v7
  v_add_u32 v5, 6, v4
  v_xor_b32 v5, v5, v3
  v_lshl_add_u32 v6, v5, 4, v2
  v_xor_b32 v7, 0x1000, v6
  v_add_u32 v203, 0, v6
  v_add_u32 v207, 0, v7
  v_add_u32 v211, 45184, v6
  v_add_u32 v215, 45184, v7
  v_add_u32 v219, 90368, v6
  v_add_u32 v223, 90368, v7
  v_and_b32 v2, 15, v1
  v_lshrrev_b32 v3, 2, v2
  v_lshrrev_b32 v4, 5, v1
  v_lshl_add_u32 v3, v4, 3, v3
  v_mul_u32_u24 v3, 224, v3
  v_and_b32 v4, 3, v1
  v_lshl_add_u32 v3, v4, 3, v3
  v_bfe_u32 v4, v1, 4, 1
  v_mul_u32_u24 v4, 14464, v4
  v_add_u32 v3, v3, v4
  s_mul_i32 s66, s73, 96
  v_add_u32 v4, s66, v3
  v_add_u32 v224, 16384, v4
  v_add_u32 v225, 16576, v3
  v_add_u32 v226, 61568, v4
  v_add_u32 v227, 61760, v3
  v_add_u32 v228, 106752, v4
  v_add_u32 v229, 106944, v3
  s_waitcnt lgkmcnt(0)
  s_add_u32 s61, s61, 1
  s_waitcnt vmcnt(1)
  s_barrier
  s_add_u32 m0, s78, 0
  s_mov_b32 s75, 0
  buffer_load_dwordx4 v16, s[8:11], s75 offen lds
  s_add_u32 m0, s78, 1024
  s_mov_b32 s75, 8192
  buffer_load_dwordx4 v17, s[8:11], s75 offen lds
  s_add_u32 m0, s78, 2048
  s_mov_b32 s75, 16384
  buffer_load_dwordx4 v16, s[8:11], s75 offen lds
  s_add_u32 m0, s78, 3072
  s_mov_b32 s75, 24576
  buffer_load_dwordx4 v17, s[8:11], s75 offen lds
  s_add_u32 m0, s78, 45184
  s_mov_b32 s75, 128
  buffer_load_dwordx4 v16, s[8:11], s75 offen lds
  s_add_u32 m0, s78, 46208
  s_mov_b32 s75, 8320
  buffer_load_dwordx4 v17, s[8:11], s75 offen lds
  s_add_u32 m0, s78, 47232
  s_mov_b32 s75, 16512
  buffer_load_dwordx4 v16, s[8:11], s75 offen lds
  s_add_u32 m0, s78, 48256
  s_mov_b32 s75, 24704
  buffer_load_dwordx4 v17, s[8:11], s75 offen lds
  s_cmp_ge_u32 s60, 2
  s_cbranch_scc0 Q1_4
  v_mad_u64_u32 v[14:15], s[68:69], v12, s60, v[10:11]
  s_nop 0
  global_load_dword v254, v[14:15], off
Q1_4:
  s_waitcnt vmcnt(4)
  s_barrier
  v_mov_b32 v40, v200
  v_mov_b32 v41, v201
  v_mov_b32 v42, v202
  v_mov_b32 v43, v203
  v_mov_b32 v44, v204
  v_mov_b32 v45, v205
  v_mov_b32 v46, v206
  v_mov_b32 v47, v207
  v_mov_b32 v48, v224
  v_mov_b32 v49, v225
  v_mov_b32 v50, v208
  v_mov_b32 v51, v212
  v_mov_b32 v52, v226
  v_mov_b32 v53, v227
  ds_read_b128 v[176:179], v40
  ds_read_b128 v[180:183], v44
  ds_read_b64_tr_b16 v[184:185], v48 offset:0
  ds_read_b64_tr_b16 v[186:187], v48 offset:896
  ds_read_b64_tr_b16 v[188:189], v48 offset:32
  ds_read_b64_tr_b16 v[190:191], v48 offset:928
  ds_read_b64_tr_b16 v[192:193], v48 offset:64
  ds_read_b64_tr_b16 v[194:195], v48 offset:960
  ds_read_b64_tr_b16 v[196:197], v49 offset:0
  ds_read_b64_tr_b16 v[198:199], v49 offset:896
  s_waitcnt lgkmcnt(0)
  v_mfma_f32_32x32x16_bf16 v[64:79], v[184:187], v[176:179], 0
  ds_read_b128 v[230:233], v41
  ds_read_b128 v[234:237], v45
  v_mfma_f32_32x32x16_bf16 v[112:127], v[184:187], v[180:183], 0
  ds_read_b64_tr_b16 v[238:239], v48 offset:3584
  ds_read_b64_tr_b16 v[240:241], v48 offset:4480
  v_mfma_f32_32x32x16_bf16 v[80:95], v[188:191], v[176:179], 0
  ds_read_b64_tr_b16 v[242:243], v48 offset:3616
  ds_read_b64_tr_b16 v[244:245], v48 offset:4512
  v_mfma_f32_32x32x16_bf16 v[128:143], v[188:191], v[180:183], 0
  ds_read_b64_tr_b16 v[246:247], v48 offset:3648
  ds_read_b64_tr_b16 v[248:249], v48 offset:4544
  v_mfma_f32_32x32x16_bf16 v[96:111], v[192:195], v[176:179], 0
  ds_read_b64_tr_b16 v[250:251], v49 offset:3584
  ds_read_b64_tr_b16 v[252:253], v49 offset:4480
  s_add_u32 m0, s78, 90368
  s_mov_b32 s75, 256
  buffer_load_dwordx4 v16, s[8:11], s75 offen lds
  v_mfma_f32_32x32x16_bf16 v[144:159], v[192:195], v[180:183], 0
  s_add_u32 m0, s78, 91392
  s_mov_b32 s75, 8448
  buffer_load_dwordx4 v17, s[8:11], s75 offen lds
  v_mfma_f32_32x32x16_bf16 v[160:175], v[196:199], v[176:179], 0
  s_waitcnt lgkmcnt(0)
  v_mfma_f32_32x32x16_bf16 v[64:79], v[238:241], v[230:233], v[64:79]
  ds_read_b128 v[176:179], v42
  ds_read_b128 v[180:183], v46
  v_mfma_f32_32x32x16_bf16 v[112:127], v[238:241], v[234:237], v[112:127]
  ds_read_b64_tr_b16 v[184:185], v48 offset:7168
  ds_read_b64_tr_b16 v[186:187], v48 offset:8064
  v_mfma_f32_32x32x16_bf16 v[80:95], v[242:245], v[230:233], v[80:95]
  ds_read_b64_tr_b16 v[188:189], v48 offset:7200
  ds_read_b64_tr_b16 v[190:191], v48 offset:8096
  v_mfma_f32_32x32x16_bf16 v[128:143], v[242:245], v[234:237], v[128:143]
  ds_read_b64_tr_b16 v[192:193], v48 offset:7232
  ds_read_b64_tr_b16 v[194:195], v48 offset:8128
  v_mfma_f32_32x32x16_bf16 v[96:111], v[246:249], v[230:233], v[96:111]
  ds_read_b64_tr_b16 v[196:197], v49 offset:7168
  ds_read_b64_tr_b16 v[198:199], v49 offset:8064
  s_add_u32 m0, s78, 92416
  s_mov_b32 s75, 16640
  buffer_load_dwordx4 v16, s[8:11], s75 offen lds
  v_mfma_f32_32x32x16_bf16 v[144:159], v[246:249], v[234:237], v[144:159]
  s_add_u32 m0, s78, 93440
  s_mov_b32 s75, 24832
  buffer_load_dwordx4 v17, s[8:11], s75 offen lds
  v_mfma_f32_32x32x16_bf16 v[160:175], v[250:253], v[230:233], v[160:175]
  s_waitcnt lgkmcnt(0)
  v_mfma_f32_32x32x16_bf16 v[64:79], v[184:187], v[176:179], v[64:79]
  ds_read_b128 v[230:233], v43
  ds_read_b128 v[234:237], v47
  v_mfma_f32_32x32x16_bf16 v[112:127], v[184:187], v[180:183], v[112:127]
  ds_read_b64_tr_b16 v[238:239], v48 offset:10752
  ds_read_b64_tr_b16 v[240:241], v48 offset:11648
  v_mfma_f32_32x32x16_bf16 v[80:95], v[188:191], v[176:179], v[80:95]
  ds_read_b64_tr_b16 v[242:243], v48 offset:10784
  ds_read_b64_tr_b16 v[244:245], v48 offset:11680
  v_mfma_f32_32x32x16_bf16 v[128:143], v[188:191], v[180:183], v[128:143]
  ds_read_b64_tr_b16 v[246:247], v48 offset:10816
  ds_read_b64_tr_b16 v[248:249], v48 offset:11712
  v_mfma_f32_32x32x16_bf16 v[96:111], v[192:195], v[176:179], v[96:111]
  ds_read_b64_tr_b16 v[250:251], v49 offset:10752
  ds_read_b64_tr_b16 v[252:253], v49 offset:11648
  v_mfma_f32_32x32x16_bf16 v[144:159], v[192:195], v[180:183], v[144:159]
  v_mfma_f32_32x32x16_bf16 v[160:175], v[196:199], v[176:179], v[160:175]
  s_waitcnt lgkmcnt(0)
  s_waitcnt vmcnt(4)
  s_barrier
  v_mfma_f32_32x32x16_bf16 v[64:79], v[238:241], v[230:233], v[64:79]
  ds_read_b128 v[176:179], v50
  ds_read_b128 v[180:183], v51
  v_mfma_f32_32x32x16_bf16 v[112:127], v[238:241], v[234:237], v[112:127]
  ds_read_b64_tr_b16 v[184:185], v52 offset:0
  ds_read_b64_tr_b16 v[186:187], v52 offset:896
  v_mfma_f32_32x32x16_bf16 v[80:95], v[242:245], v[230:233], v[80:95]
  ds_read_b64_tr_b16 v[188:189], v52 offset:32
  ds_read_b64_tr_b16 v[190:191], v52 offset:928
  v_mfma_f32_32x32x16_bf16 v[128:143], v[242:245], v[234:237], v[128:143]
  ds_read_b64_tr_b16 v[192:193], v52 offset:64
  ds_read_b64_tr_b16 v[194:195], v52 offset:960
  v_mfma_f32_32x32x16_bf16 v[96:111], v[246:249], v[230:233], v[96:111]
  ds_read_b64_tr_b16 v[196:197], v53 offset:0
  ds_read_b64_tr_b16 v[198:199], v53 offset:896
  s_add_u32 m0, s78, 0
  s_mov_b32 s75, 384
  buffer_load_dwordx4 v16, s[8:11], s75 offen lds
  v_mfma_f32_32x32x16_bf16 v[144:159], v[246:249], v[234:237], v[144:159]
  v_mfma_f32_32x32x16_bf16 v[160:175], v[250:253], v[230:233], v[160:175]
  s_mov_b32 s87, 1
  s_mov_b32 s88, 45184
  s_add_u32 s84, s78, 0
  s_mov_b32 s85, 384
L_C3:
  s_add_u32 s89, s88, 45184
  s_cmp_eq_u32 s89, 135552
  s_cselect_b32 s89, 0, s89
  v_add_u32 v40, s88, v200
  v_add_u32 v41, s88, v201
  v_add_u32 v42, s88, v202
  v_add_u32 v43, s88, v203
  v_add_u32 v44, s88, v204
  v_add_u32 v45, s88, v205
  v_add_u32 v46, s88, v206
  v_add_u32 v47, s88, v207
  v_add_u32 v48, s88, v224
  v_add_u32 v49, s88, v225
  v_add_u32 v50, s89, v200
  v_add_u32 v51, s89, v204
  v_add_u32 v52, s89, v224
  v_add_u32 v53, s89, v225
  s_waitcnt lgkmcnt(0)
  v_mfma_f32_32x32x16_bf16 v[64:79], v[184:187], v[176:179], v[64:79]
  ds_read_b128 v[230:233], v41
  ds_read_b128 v[234:237], v45
  v_mfma_f32_32x32x16_bf16 v[112:127], v[184:187], v[180:183], v[112:127]
  ds_read_b64_tr_b16 v[238:239], v48 offset:3584
  ds_read_b64_tr_b16 v[240:241], v48 offset:4480
  v_mfma_f32_32x32x16_bf16 v[80:95], v[188:191], v[176:179], v[80:95]
  ds_read_b64_tr_b16 v[242:243], v48 offset:3616
  ds_read_b64_tr_b16 v[244:245], v48 offset:4512
  v_mfma_f32_32x32x16_bf16 v[128:143], v[188:191], v[180:183], v[128:143]
  ds_read_b64_tr_b16 v[246:247], v48 offset:3648
  ds_read_b64_tr_b16 v[248:249], v48 offset:4544
  v_mfma_f32_32x32x16_bf16 v[96:111], v[192:195], v[176:179], v[96:111]
  ds_read_b64_tr_b16 v[250:251], v49 offset:3584
  ds_read_b64_tr_b16 v[252:253], v49 offset:4480
  s_cmp_le_u32 s87, 5
  s_cbranch_scc0 L_C3s0
  s_add_u32 m0, s84, 1024
  s_add_u32 s75, s85, 8192
  buffer_load_dwordx4 v17, s[8:11], s75 offen lds
L_C3s0:
  v_mfma_f32_32x32x16_bf16 v[144:159], v[192:195], v[180:183], v[144:159]
  v_mfma_f32_32x32x16_bf16 v[160:175], v[196:199], v[176:179], v[160:175]
  s_waitcnt lgkmcnt(0)
  v_mfma_f32_32x32x16_bf16 v[64:79], v[238:241], v[230:233], v[64:79]
  ds_read_b128 v[176:179], v42
  ds_read_b128 v[180:183], v46
  v_mfma_f32_32x32x16_bf16 v[112:127], v[238:241], v[234:237], v[112:127]
  ds_read_b64_tr_b16 v[184:185], v48 offset:7168
  ds_read_b64_tr_b16 v[186:187], v48 offset:8064
  v_mfma_f32_32x32x16_bf16 v[80:95], v[242:245], v[230:233], v[80:95]
  ds_read_b64_tr_b16 v[188:189], v48 offset:7200
  ds_read_b64_tr_b16 v[190:191], v48 offset:8096
  v_mfma_f32_32x32x16_bf16 v[128:143], v[242:245], v[234:237], v[128:143]
  ds_read_b64_tr_b16 v[192:193], v48 offset:7232
  ds_read_b64_tr_b16 v[194:195], v48 offset:8128
  v_mfma_f32_32x32x16_bf16 v[96:111], v[246:249], v[230:233], v[96:111]
  ds_read_b64_tr_b16 v[196:197], v49 offset:7168
  ds_read_b64_tr_b16 v[198:199], v49 offset:8064
  s_cmp_le_u32 s87, 5
  s_cbranch_scc0 L_C3s1
  s_add_u32 m0, s84, 2048
  s_add_u32 s75, s85, 16384
  buffer_load_dwordx4 v16, s[8:11], s75 offen lds
L_C3s1:
  v_mfma_f32_32x32x16_bf16 v[144:159], v[246:249], v[234:237], v[144:159]
  v_mfma_f32_32x32x16_bf16 v[160:175], v[250:253], v[230:233], v[160:175]
  s_waitcnt lgkmcnt(0)
  v_mfma_f32_32x32x16_bf16 v[64:79], v[184:187], v[176:179], v[64:79]
  ds_read_b128 v[230:233], v43
  ds_read_b128 v[234:237], v47
  v_mfma_f32_32x32x16_bf16 v[112:127], v[184:187], v[180:183], v[112:127]
  ds_read_b64_tr_b16 v[238:239], v48 offset:10752
  ds_read_b64_tr_b16 v[240:241], v48 offset:11648
  v_mfma_f32_32x32x16_bf16 v[80:95], v[188:191], v[176:179], v[80:95]
  ds_read_b64_tr_b16 v[242:243], v48 offset:10784
  ds_read_b64_tr_b16 v[244:245], v48 offset:11680
  v_mfma_f32_32x32x16_bf16 v[128:143], v[188:191], v[180:183], v[128:143]
  ds_read_b64_tr_b16 v[246:247], v48 offset:10816
  ds_read_b64_tr_b16 v[248:249], v48 offset:11712
  v_mfma_f32_32x32x16_bf16 v[96:111], v[192:195], v[176:179], v[96:111]
  ds_read_b64_tr_b16 v[250:251], v49 offset:10752
  ds_read_b64_tr_b16 v[252:253], v49 offset:11648
  s_cmp_le_u32 s87, 5
  s_cbranch_scc0 L_C3s2
  s_add_u32 m0, s84, 3072
  s_add_u32 s75, s85, 24576
  buffer_load_dwordx4 v17, s[8:11], s75 offen lds
L_C3s2:
  v_mfma_f32_32x32x16_bf16 v[144:159], v[192:195], v[180:183], v[144:159]
  v_mfma_f32_32x32x16_bf16 v[160:175], v[196:199], v[176:179], v[160:175]
  s_waitcnt lgkmcnt(0)
  s_cmp_eq_u32 s87, 6
  s_cbranch_scc1 L_C3z
  s_waitcnt vmcnt(4)
  s_branch L_C3y
L_C3z:
  s_waitcnt vmcnt(0)
L_C3y:
  s_barrier
  s_add_u32 s84, s78, s88
  s_add_u32 s85, s85, 128
  v_mfma_f32_32x32x16_bf16 v[64:79], v[238:241], v[230:233], v[64:79]
  ds_read_b128 v[176:179], v50
  ds_read_b128 v[180:183], v51
  v_mfma_f32_32x32x16_bf16 v[112:127], v[238:241], v[234:237], v[112:127]
  ds_read_b64_tr_b16 v[184:185], v52 offset:0
  ds_read_b64_tr_b16 v[186:187], v52 offset:896
  v_mfma_f32_32x32x16_bf16 v[80:95], v[242:245], v[230:233], v[80:95]
  ds_read_b64_tr_b16 v[188:189], v52 offset:32
  ds_read_b64_tr_b16 v[190:191], v52 offset:928
  v_mfma_f32_32x32x16_bf16 v[128:143], v[242:245], v[234:237], v[128:143]
  ds_read_b64_tr_b16 v[192:193], v52 offset:64
  ds_read_b64_tr_b16 v[194:195], v52 offset:960
  v_mfma_f32_32x32x16_bf16 v[96:111], v[246:249], v[230:233], v[96:111]
  ds_read_b64_tr_b16 v[196:197], v53 offset:0
  ds_read_b64_tr_b16 v[198:199], v53 offset:896
  s_cmp_le_u32 s87, 4
  s_cbranch_scc0 L_C3s3
  s_add_u32 m0, s84, 0
  s_add_u32 s75, s85, 0
  buffer_load_dwordx4 v16, s[8:11], s75 offen lds
L_C3s3:
  v_mfma_f32_32x32x16_bf16 v[144:159], v[246:249], v[234:237], v[144:159]
  v_mfma_f32_32x32x16_bf16 v[160:175], v[250:253], v[230:233], v[160:175]
  s_mov_b32 s88, s89
  s_add_u32 s87, s87, 1
  s_cmp_le_u32 s87, 6
  s_cbranch_scc1 L_C3
  v_add_u32 v40, s88, v200
  v_add_u32 v41, s88, v201
  v_add_u32 v42, s88, v202
  v_add_u32 v43, s88, v203
  v_add_u32 v44, s88, v204
  v_add_u32 v45, s88, v205
  v_add_u32 v46, s88, v206
  v_add_u32 v47, s88, v207
  v_add_u32 v48, s88, v224
  v_add_u32 v49, s88, v225
  s_waitcnt lgkmcnt(0)
  v_mfma_f32_32x32x16_bf16 v[64:79], v[184:187], v[176:179], v[64:79]
  ds_read_b128 v[230:233], v41
  ds_read_b128 v[234:237], v45
  v_mfma_f32_32x32x16_bf16 v[112:127], v[184:187], v[180:183], v[112:127]
  ds_read_b64_tr_b16 v[238:239], v48 offset:3584
  ds_read_b64_tr_b16 v[240:241], v48 offset:4480
  v_mfma_f32_32x32x16_bf16 v[80:95], v[188:191], v[176:179], v[80:95]
  ds_read_b64_tr_b16 v[242:243], v48 offset:3616
  ds_read_b64_tr_b16 v[244:245], v48 offset:4512
  v_mfma_f32_32x32x16_bf16 v[128:143], v[188:191], v[180:183], v[128:143]
  ds_read_b64_tr_b16 v[246:247], v48 offset:3648
  ds_read_b64_tr_b16 v[248:249], v48 offset:4544
  v_mfma_f32_32x32x16_bf16 v[96:111], v[192:195], v[176:179], v[96:111]
  ds_read_b64_tr_b16 v[250:251], v49 offset:3584
  ds_read_b64_tr_b16 v[252:253], v49 offset:4480
  v_mfma_f32_32x32x16_bf16 v[144:159], v[192:195], v[180:183], v[144:159]
  v_mfma_f32_32x32x16_bf16 v[160:175], v[196:199], v[176:179], v[160:175]
  s_waitcnt lgkmcnt(0)
  v_mfma_f32_32x32x16_bf16 v[64:79], v[238:241], v[230:233], v[64:79]
  ds_read_b128 v[176:179], v42
  ds_read_b128 v[180:183], v46
  v_mfma_f32_32x32x16_bf16 v[112:127], v[238:241], v[234:237], v[112:127]
  ds_read_b64_tr_b16 v[184:185], v48 offset:7168
  ds_read_b64_tr_b16 v[186:187], v48 offset:8064
  v_mfma_f32_32x32x16_bf16 v[80:95], v[242:245], v[230:233], v[80:95]
  ds_read_b64_tr_b16 v[188:189], v48 offset:7200
  ds_read_b64_tr_b16 v[190:191], v48 offset:8096
  v_mfma_f32_32x32x16_bf16 v[128:143], v[242:245], v[234:237], v[128:143]
  ds_read_b64_tr_b16 v[192:193], v48 offset:7232
  ds_read_b64_tr_b16 v[194:195], v48 offset:8128
  v_mfma_f32_32x32x16_bf16 v[96:111], v[246:249], v[230:233], v[96:111]
  ds_read_b64_tr_b16 v[196:197], v49 offset:7168
  ds_read_b64_tr_b16 v[198:199], v49 offset:8064
  v_mfma_f32_32x32x16_bf16 v[144:159], v[246:249], v[234:237], v[144:159]
  v_mfma_f32_32x32x16_bf16 v[160:175], v[250:253], v[230:233], v[160:175]
  s_waitcnt lgkmcnt(0)
  v_mfma_f32_32x32x16_bf16 v[64:79], v[184:187], v[176:179], v[64:79]
  ds_read_b128 v[230:233], v43
  ds_read_b128 v[234:237], v47
  v_mfma_f32_32x32x16_bf16 v[112:127], v[184:187], v[180:183], v[112:127]
  ds_read_b64_tr_b16 v[238:239], v48 offset:10752
  ds_read_b64_tr_b16 v[240:241], v48 offset:11648
  v_mfma_f32_32x32x16_bf16 v[80:95], v[188:191], v[176:179], v[80:95]
  ds_read_b64_tr_b16 v[242:243], v48 offset:10784
  ds_read_b64_tr_b16 v[244:245], v48 offset:11680
  v_mfma_f32_32x32x16_bf16 v[128:143], v[188:191], v[180:183], v[128:143]
  ds_read_b64_tr_b16 v[246:247], v48 offset:10816
  ds_read_b64_tr_b16 v[248:249], v48 offset:11712
  v_mfma_f32_32x32x16_bf16 v[96:111], v[192:195], v[176:179], v[96:111]
  ds_read_b64_tr_b16 v[250:251], v49 offset:10752
  ds_read_b64_tr_b16 v[252:253], v49 offset:11648
  v_mfma_f32_32x32x16_bf16 v[144:159], v[192:195], v[180:183], v[144:159]
  v_mfma_f32_32x32x16_bf16 v[160:175], v[196:199], v[176:179], v[160:175]
  s_waitcnt lgkmcnt(0)
  v_mfma_f32_32x32x16_bf16 v[64:79], v[238:241], v[230:233], v[64:79]
  v_mfma_f32_32x32x16_bf16 v[112:127], v[238:241], v[234:237], v[112:127]
  v_mfma_f32_32x32x16_bf16 v[80:95], v[242:245], v[230:233], v[80:95]
  v_mfma_f32_32x32x16_bf16 v[128:143], v[242:245], v[234:237], v[128:143]
  v_mfma_f32_32x32x16_bf16 v[96:111], v[246:249], v[230:233], v[96:111]
  v_mfma_f32_32x32x16_bf16 v[144:159], v[246:249], v[234:237], v[144:159]
  v_mfma_f32_32x32x16_bf16 v[160:175], v[250:253], v[230:233], v[160:175]
  s_lshl_b32 s66, s2, 2
  v_mov_b32 v5, s66
  buffer_load_dword v250, v5, s[48:51], 0 offen
  v_mov_b32 v4, 0xbdd2d3e8
  v_mov_b32 v5, 0xbdd2d3e8
  v_mov_b32 v6, 0xc0135761
  v_mov_b32 v7, 0xc0135761
  v_mov_b32 v8, 1.0
  v_mov_b32 v9, 1.0
  s_lshl_b32 s69, s64, 2
  s_add_u32 s66, s69, s74
  s_xor_b32 s67, s74, 1
  s_add_u32 s67, s69, s67
  s_mul_i32 s66, s66, 112
  s_mul_i32 s67, s67, 112
  s_mul_i32 s69, s65, 7
  s_add_u32 s66, s66, s69
  s_add_u32 s67, s67, s69
  s_add_u32 s68, s66, 6
  s_mul_i32 s69, s73, 3
  s_add_u32 s66, s66, s69
  s_add_u32 s67, s67, s69
  s_lshl_b32 s66, s66, 10
  s_lshl_b32 s67, s67, 10
  s_lshl_b32 s68, s68, 10
  s_add_u32 s66, s66, 2162688
  s_add_u32 s67, s67, 2162688
  s_add_u32 s68, s68, 2162688
  v_lshlrev_b32 v10, 4, v1
  s_nop 7
  v_pk_mul_f32 v[20:21], v[160:161], v[160:161]
  v_pk_mul_f32 v[22:23], v[162:163], v[162:163]
  v_pk_mul_f32 v[24:25], v[164:165], v[164:165]
  v_pk_mul_f32 v[26:27], v[166:167], v[166:167]
  v_pk_fma_f32 v[20:21], v[20:21], v[4:5], v[6:7]
  v_pk_fma_f32 v[22:23], v[22:23], v[4:5], v[6:7]
  v_pk_fma_f32 v[24:25], v[24:25], v[4:5], v[6:7]
  v_pk_fma_f32 v[26:27], v[26:27], v[4:5], v[6:7]
  v_pk_mul_f32 v[20:21], v[20:21], v[160:161]
  v_pk_mul_f32 v[22:23], v[22:23], v[162:163]
  v_pk_mul_f32 v[24:25], v[24:25], v[164:165]
  v_pk_mul_f32 v[26:27], v[26:27], v[166:167]
  v_exp_f32 v20, v20
  v_exp_f32 v21, v21
  v_exp_f32 v22, v22
  v_exp_f32 v23, v23
  v_exp_f32 v24, v24
  v_exp_f32 v25, v25
  v_exp_f32 v26, v26
  v_exp_f32 v27, v27
  v_pk_mul_f32 v[160:161], v[160:161], v[168:169]
  v_pk_mul_f32 v[162:163], v[162:163], v[170:171]
  v_pk_mul_f32 v[164:165], v[164:165], v[172:173]
  v_pk_mul_f32 v[166:167], v[166:167], v[174:175]
  v_pk_add_f32 v[20:21], v[20:21], v[8:9]
  v_pk_add_f32 v[22:23], v[22:23], v[8:9]
  v_pk_add_f32 v[24:25], v[24:25], v[8:9]
  v_pk_add_f32 v[26:27], v[26:27], v[8:9]
  v_rcp_f32 v20, v20
  v_rcp_f32 v21, v21
  v_rcp_f32 v22, v22
  v_rcp_f32 v23, v23
  v_rcp_f32 v24, v24
  v_rcp_f32 v25, v25
  v_rcp_f32 v26, v26
  v_rcp_f32 v27, v27
  s_nop 0
  v_pk_mul_f32 v[160:161], v[160:161], v[20:21]
  v_pk_mul_f32 v[162:163], v[162:163], v[22:23]
  v_pk_mul_f32 v[164:165], v[164:165], v[24:25]
  v_pk_mul_f32 v[166:167], v[166:167], v[26:27]
  v_cvt_pk_bf16_f32 v28, v160, v161
  v_cvt_pk_bf16_f32 v29, v162, v163
  v_cvt_pk_bf16_f32 v30, v164, v165
  v_cvt_pk_bf16_f32 v31, v166, v167
  buffer_store_dwordx4 v[28:31], v10, s[4:7], s68 offen offset:0 sc1
  v_pk_mul_f32 v[32:33], v[64:65], v[64:65]
  v_pk_mul_f32 v[34:35], v[66:67], v[66:67]
  v_pk_mul_f32 v[36:37], v[68:69], v[68:69]
  v_pk_mul_f32 v[38:39], v[70:71], v[70:71]
  v_pk_fma_f32 v[32:33], v[32:33], v[4:5], v[6:7]
  v_pk_fma_f32 v[34:35], v[34:35], v[4:5], v[6:7]
  v_pk_fma_f32 v[36:37], v[36:37], v[4:5], v[6:7]
  v_pk_fma_f32 v[38:39], v[38:39], v[4:5], v[6:7]
  v_pk_mul_f32 v[32:33], v[32:33], v[64:65]
  v_pk_mul_f32 v[34:35], v[34:35], v[66:67]
  v_pk_mul_f32 v[36:37], v[36:37], v[68:69]
  v_pk_mul_f32 v[38:39], v[38:39], v[70:71]
  v_exp_f32 v32, v32
  v_exp_f32 v33, v33
  v_exp_f32 v34, v34
  v_exp_f32 v35, v35
  v_exp_f32 v36, v36
  v_exp_f32 v37, v37
  v_exp_f32 v38, v38
  v_exp_f32 v39, v39
  v_pk_mul_f32 v[64:65], v[64:65], v[72:73]
  v_pk_mul_f32 v[66:67], v[66:67], v[74:75]
  v_pk_mul_f32 v[68:69], v[68:69], v[76:77]
  v_pk_mul_f32 v[70:71], v[70:71], v[78:79]
  v_pk_add_f32 v[32:33], v[32:33], v[8:9]
  v_pk_add_f32 v[34:35], v[34:35], v[8:9]
  v_pk_add_f32 v[36:37], v[36:37], v[8:9]
  v_pk_add_f32 v[38:39], v[38:39], v[8:9]
  v_rcp_f32 v32, v32
  v_rcp_f32 v33, v33
  v_rcp_f32 v34, v34
  v_rcp_f32 v35, v35
  v_rcp_f32 v36, v36
  v_rcp_f32 v37, v37
  v_rcp_f32 v38, v38
  v_rcp_f32 v39, v39
  s_nop 0
  v_pk_mul_f32 v[64:65], v[64:65], v[32:33]
  v_pk_mul_f32 v[66:67], v[66:67], v[34:35]
  v_pk_mul_f32 v[68:69], v[68:69], v[36:37]
  v_pk_mul_f32 v[70:71], v[70:71], v[38:39]
  v_cvt_pk_bf16_f32 v40, v64, v65
  v_cvt_pk_bf16_f32 v41, v66, v67
  v_cvt_pk_bf16_f32 v42, v68, v69
  v_cvt_pk_bf16_f32 v43, v70, v71
  buffer_store_dwordx4 v[40:43], v10, s[4:7], s66 offen offset:0 sc1
  v_pk_mul_f32 v[20:21], v[112:113], v[112:113]
  v_pk_mul_f32 v[22:23], v[114:115], v[114:115]
  v_pk_mul_f32 v[24:25], v[116:117], v[116:117]
  v_pk_mul_f32 v[26:27], v[118:119], v[118:119]
  v_pk_fma_f32 v[20:21], v[20:21], v[4:5], v[6:7]
  v_pk_fma_f32 v[22:23], v[22:23], v[4:5], v[6:7]
  v_pk_fma_f32 v[24:25], v[24:25], v[4:5], v[6:7]
  v_pk_fma_f32 v[26:27], v[26:27], v[4:5], v[6:7]
  v_pk_mul_f32 v[20:21], v[20:21], v[112:113]
  v_pk_mul_f32 v[22:23], v[22:23], v[114:115]
  v_pk_mul_f32 v[24:25], v[24:25], v[116:117]
  v_pk_mul_f32 v[26:27], v[26:27], v[118:119]
  v_exp_f32 v20, v20
  v_exp_f32 v21, v21
  v_exp_f32 v22, v22
  v_exp_f32 v23, v23
  v_exp_f32 v24, v24
  v_exp_f32 v25, v25
  v_exp_f32 v26, v26
  v_exp_f32 v27, v27
  v_pk_mul_f32 v[112:113], v[112:113], v[120:121]
  v_pk_mul_f32 v[114:115], v[114:115], v[122:123]
  v_pk_mul_f32 v[116:117], v[116:117], v[124:125]
  v_pk_mul_f32 v[118:119], v[118:119], v[126:127]
  v_pk_add_f32 v[20:21], v[20:21], v[8:9]
  v_pk_add_f32 v[22:23], v[22:23], v[8:9]
  v_pk_add_f32 v[24:25], v[24:25], v[8:9]
  v_pk_add_f32 v[26:27], v[26:27], v[8:9]
  v_rcp_f32 v20, v20
  v_rcp_f32 v21, v21
  v_rcp_f32 v22, v22
  v_rcp_f32 v23, v23
  v_rcp_f32 v24, v24
  v_rcp_f32 v25, v25
  v_rcp_f32 v26, v26
  v_rcp_f32 v27, v27
  s_nop 0
  v_pk_mul_f32 v[112:113], v[112:113], v[20:21]
  v_pk_mul_f32 v[114:115], v[114:115], v[22:23]
  v_pk_mul_f32 v[116:117], v[116:117], v[24:25]
  v_pk_mul_f32 v[118:119], v[118:119], v[26:27]
  v_cvt_pk_bf16_f32 v28, v112, v113
  v_cvt_pk_bf16_f32 v29, v114, v115
  v_cvt_pk_bf16_f32 v30, v116, v117
  v_cvt_pk_bf16_f32 v31, v118, v119
  buffer_store_dwordx4 v[28:31], v10, s[4:7], s67 offen offset:0 sc1
  v_pk_mul_f32 v[32:33], v[80:81], v[80:81]
  v_pk_mul_f32 v[34:35], v[82:83], v[82:83]
  v_pk_mul_f32 v[36:37], v[84:85], v[84:85]
  v_pk_mul_f32 v[38:39], v[86:87], v[86:87]
  v_pk_fma_f32 v[32:33], v[32:33], v[4:5], v[6:7]
  v_pk_fma_f32 v[34:35], v[34:35], v[4:5], v[6:7]
  v_pk_fma_f32 v[36:37], v[36:37], v[4:5], v[6:7]
  v_pk_fma_f32 v[38:39], v[38:39], v[4:5], v[6:7]
  v_pk_mul_f32 v[32:33], v[32:33], v[80:81]
  v_pk_mul_f32 v[34:35], v[34:35], v[82:83]
  v_pk_mul_f32 v[36:37], v[36:37], v[84:85]
  v_pk_mul_f32 v[38:39], v[38:39], v[86:87]
  v_exp_f32 v32, v32
  v_exp_f32 v33, v33
  v_exp_f32 v34, v34
  v_exp_f32 v35, v35
  v_exp_f32 v36, v36
  v_exp_f32 v37, v37
  v_exp_f32 v38, v38
  v_exp_f32 v39, v39
  v_pk_mul_f32 v[80:81], v[80:81], v[88:89]
  v_pk_mul_f32 v[82:83], v[82:83], v[90:91]
  v_pk_mul_f32 v[84:85], v[84:85], v[92:93]
  v_pk_mul_f32 v[86:87], v[86:87], v[94:95]
  v_pk_add_f32 v[32:33], v[32:33], v[8:9]
  v_pk_add_f32 v[34:35], v[34:35], v[8:9]
  v_pk_add_f32 v[36:37], v[36:37], v[8:9]
  v_pk_add_f32 v[38:39], v[38:39], v[8:9]
  v_rcp_f32 v32, v32
  v_rcp_f32 v33, v33
  v_rcp_f32 v34, v34
  v_rcp_f32 v35, v35
  v_rcp_f32 v36, v36
  v_rcp_f32 v37, v37
  v_rcp_f32 v38, v38
  v_rcp_f32 v39, v39
  s_nop 0
  v_pk_mul_f32 v[80:81], v[80:81], v[32:33]
  v_pk_mul_f32 v[82:83], v[82:83], v[34:35]
  v_pk_mul_f32 v[84:85], v[84:85], v[36:37]
  v_pk_mul_f32 v[86:87], v[86:87], v[38:39]
  v_cvt_pk_bf16_f32 v40, v80, v81
  v_cvt_pk_bf16_f32 v41, v82, v83
  v_cvt_pk_bf16_f32 v42, v84, v85
  v_cvt_pk_bf16_f32 v43, v86, v87
  buffer_store_dwordx4 v[40:43], v10, s[4:7], s66 offen offset:1024 sc1
  v_pk_mul_f32 v[20:21], v[128:129], v[128:129]
  v_pk_mul_f32 v[22:23], v[130:131], v[130:131]
  v_pk_mul_f32 v[24:25], v[132:133], v[132:133]
  v_pk_mul_f32 v[26:27], v[134:135], v[134:135]
  v_pk_fma_f32 v[20:21], v[20:21], v[4:5], v[6:7]
  v_pk_fma_f32 v[22:23], v[22:23], v[4:5], v[6:7]
  v_pk_fma_f32 v[24:25], v[24:25], v[4:5], v[6:7]
  v_pk_fma_f32 v[26:27], v[26:27], v[4:5], v[6:7]
  v_pk_mul_f32 v[20:21], v[20:21], v[128:129]
  v_pk_mul_f32 v[22:23], v[22:23], v[130:131]
  v_pk_mul_f32 v[24:25], v[24:25], v[132:133]
  v_pk_mul_f32 v[26:27], v[26:27], v[134:135]
  v_exp_f32 v20, v20
  v_exp_f32 v21, v21
  v_exp_f32 v22, v22
  v_exp_f32 v23, v23
  v_exp_f32 v24, v24
  v_exp_f32 v25, v25
  v_exp_f32 v26, v26
  v_exp_f32 v27, v27
  v_pk_mul_f32 v[128:129], v[128:129], v[136:137]
  v_pk_mul_f32 v[130:131], v[130:131], v[138:139]
  v_pk_mul_f32 v[132:133], v[132:133], v[140:141]
  v_pk_mul_f32 v[134:135], v[134:135], v[142:143]
  v_pk_add_f32 v[20:21], v[20:21], v[8:9]
  v_pk_add_f32 v[22:23], v[22:23], v[8:9]
  v_pk_add_f32 v[24:25], v[24:25], v[8:9]
  v_pk_add_f32 v[26:27], v[26:27], v[8:9]
  v_rcp_f32 v20, v20
  v_rcp_f32 v21, v21
  v_rcp_f32 v22, v22
  v_rcp_f32 v23, v23
  v_rcp_f32 v24, v24
  v_rcp_f32 v25, v25
  v_rcp_f32 v26, v26
  v_rcp_f32 v27, v27
  s_nop 0
  v_pk_mul_f32 v[128:129], v[128:129], v[20:21]
  v_pk_mul_f32 v[130:131], v[130:131], v[22:23]
  v_pk_mul_f32 v[132:133], v[132:133], v[24:25]
  v_pk_mul_f32 v[134:135], v[134:135], v[26:27]
  v_cvt_pk_bf16_f32 v28, v128, v129
  v_cvt_pk_bf16_f32 v29, v130, v131
  v_cvt_pk_bf16_f32 v30, v132, v133
  v_cvt_pk_bf16_f32 v31, v134, v135
  buffer_store_dwordx4 v[28:31], v10, s[4:7], s67 offen offset:1024 sc1
  v_pk_mul_f32 v[32:33], v[96:97], v[96:97]
  v_pk_mul_f32 v[34:35], v[98:99], v[98:99]
  v_pk_mul_f32 v[36:37], v[100:101], v[100:101]
  v_pk_mul_f32 v[38:39], v[102:103], v[102:103]
  v_pk_fma_f32 v[32:33], v[32:33], v[4:5], v[6:7]
  v_pk_fma_f32 v[34:35], v[34:35], v[4:5], v[6:7]
  v_pk_fma_f32 v[36:37], v[36:37], v[4:5], v[6:7]
  v_pk_fma_f32 v[38:39], v[38:39], v[4:5], v[6:7]
  v_pk_mul_f32 v[32:33], v[32:33], v[96:97]
  v_pk_mul_f32 v[34:35], v[34:35], v[98:99]
  v_pk_mul_f32 v[36:37], v[36:37], v[100:101]
  v_pk_mul_f32 v[38:39], v[38:39], v[102:103]
  v_exp_f32 v32, v32
  v_exp_f32 v33, v33
  v_exp_f32 v34, v34
  v_exp_f32 v35, v35
  v_exp_f32 v36, v36
  v_exp_f32 v37, v37
  v_exp_f32 v38, v38
  v_exp_f32 v39, v39
  v_pk_mul_f32 v[96:97], v[96:97], v[104:105]
  v_pk_mul_f32 v[98:99], v[98:99], v[106:107]
  v_pk_mul_f32 v[100:101], v[100:101], v[108:109]
  v_pk_mul_f32 v[102:103], v[102:103], v[110:111]
  v_pk_add_f32 v[32:33], v[32:33], v[8:9]
  v_pk_add_f32 v[34:35], v[34:35], v[8:9]
  v_pk_add_f32 v[36:37], v[36:37], v[8:9]
  v_pk_add_f32 v[38:39], v[38:39], v[8:9]
  v_rcp_f32 v32, v32
  v_rcp_f32 v33, v33
  v_rcp_f32 v34, v34
  v_rcp_f32 v35, v35
  v_rcp_f32 v36, v36
  v_rcp_f32 v37, v37
  v_rcp_f32 v38, v38
  v_rcp_f32 v39, v39
  s_nop 0
  v_pk_mul_f32 v[96:97], v[96:97], v[32:33]
  v_pk_mul_f32 v[98:99], v[98:99], v[34:35]
  v_pk_mul_f32 v[100:101], v[100:101], v[36:37]
  v_pk_mul_f32 v[102:103], v[102:103], v[38:39]
  v_cvt_pk_bf16_f32 v40, v96, v97
  v_cvt_pk_bf16_f32 v41, v98, v99
  v_cvt_pk_bf16_f32 v42, v100, v101
  v_cvt_pk_bf16_f32 v43, v102, v103
  buffer_store_dwordx4 v[40:43], v10, s[4:7], s66 offen offset:2048 sc1
  v_pk_mul_f32 v[20:21], v[144:145], v[144:145]
  v_pk_mul_f32 v[22:23], v[146:147], v[146:147]
  v_pk_mul_f32 v[24:25], v[148:149], v[148:149]
  v_pk_mul_f32 v[26:27], v[150:151], v[150:151]
  v_pk_fma_f32 v[20:21], v[20:21], v[4:5], v[6:7]
  v_pk_fma_f32 v[22:23], v[22:23], v[4:5], v[6:7]
  v_pk_fma_f32 v[24:25], v[24:25], v[4:5], v[6:7]
  v_pk_fma_f32 v[26:27], v[26:27], v[4:5], v[6:7]
  v_pk_mul_f32 v[20:21], v[20:21], v[144:145]
  v_pk_mul_f32 v[22:23], v[22:23], v[146:147]
  v_pk_mul_f32 v[24:25], v[24:25], v[148:149]
  v_pk_mul_f32 v[26:27], v[26:27], v[150:151]
  v_exp_f32 v20, v20
  v_exp_f32 v21, v21
  v_exp_f32 v22, v22
  v_exp_f32 v23, v23
  v_exp_f32 v24, v24
  v_exp_f32 v25, v25
  v_exp_f32 v26, v26
  v_exp_f32 v27, v27
  v_pk_mul_f32 v[144:145], v[144:145], v[152:153]
  v_pk_mul_f32 v[146:147], v[146:147], v[154:155]
  v_pk_mul_f32 v[148:149], v[148:149], v[156:157]
  v_pk_mul_f32 v[150:151], v[150:151], v[158:159]
  v_pk_add_f32 v[20:21], v[20:21], v[8:9]
  v_pk_add_f32 v[22:23], v[22:23], v[8:9]
  v_pk_add_f32 v[24:25], v[24:25], v[8:9]
  v_pk_add_f32 v[26:27], v[26:27], v[8:9]
  v_rcp_f32 v20, v20
  v_rcp_f32 v21, v21
  v_rcp_f32 v22, v22
  v_rcp_f32 v23, v23
  v_rcp_f32 v24, v24
  v_rcp_f32 v25, v25
  v_rcp_f32 v26, v26
  v_rcp_f32 v27, v27
  s_nop 0
  v_pk_mul_f32 v[144:145], v[144:145], v[20:21]
  v_pk_mul_f32 v[146:147], v[146:147], v[22:23]
  v_pk_mul_f32 v[148:149], v[148:149], v[24:25]
  v_pk_mul_f32 v[150:151], v[150:151], v[26:27]
  v_cvt_pk_bf16_f32 v28, v144, v145
  v_cvt_pk_bf16_f32 v29, v146, v147
  v_cvt_pk_bf16_f32 v30, v148, v149
  v_cvt_pk_bf16_f32 v31, v150, v151
  buffer_store_dwordx4 v[28:31], v10, s[4:7], s67 offen offset:2048 sc1
  s_mul_i32 s79, s63, 57344
  s_add_u32 s79, s79, 0
  s_mul_i32 s66, s60, 7168
  s_add_u32 s66, s66, s79
  v_min_u32 v2, 55, v1
  v_lshlrev_b32 v2, 7, v2
  buffer_load_dword v254, v2, s[20:23], s66 offen
  s_mul_i32 s79, s63, 57344
  s_add_u32 s79, s79, 28672
  s_mul_i32 s66, s60, 7168
  s_add_u32 s66, s66, s79
  v_min_u32 v2, 55, v1
  v_lshlrev_b32 v2, 7, v2
  buffer_load_dword v254, v2, s[20:23], s66 offen
  s_waitcnt lgkmcnt(0)
  s_barrier
  v_and_b32 v2, 15, v1
  v_lshrrev_b32 v3, 4, v1
  s_lshr_b32 s66, s60, 1
  s_and_b32 s67, s60, 1
  v_add_u32 v4, 1, v2
  v_and_b32 v5, 3, v4
  v_lshl_add_u32 v6, v3, 3, v4
  v_sub_u32 v6, v6, v5
  v_lshlrev_b32 v6, 1, v6
  v_mul_u32_u24 v5, 4160, v5
  v_add_u32 v6, v6, v5
  s_mul_i32 s68, s66, 16640
  s_lshl_b32 s69, s67, 8
  s_add_u32 s68, s68, s69
  s_add_u32 s68, s68, 0
  v_add_u32 v6, s68, v6
  v_lshlrev_b32 v7, 5, v2
  v_lshlrev_b32 v8, 4, v3
  v_sub_u32 v7, v8, v7
  s_mul_i32 s68, s66, 4608
  s_add_u32 s68, s68, s69
  s_add_u32 s68, s68, 33760
  v_add_u32 v7, s68, v7
  ds_read_b128 v[128:131], v7 offset:3584
  ds_read_b128 v[132:135], v7 offset:3072
  ds_read_b128 v[136:139], v7 offset:2560
  ds_read_b128 v[140:143], v7 offset:2048
  ds_read_b128 v[144:147], v7 offset:1536
  ds_read_b128 v[148:151], v7 offset:1024
  ds_read_b128 v[152:155], v7 offset:512
  ds_read_b128 v[156:159], v7 offset:0
  ds_read_b64 v[96:97], v6 offset:0
  ds_read_b64 v[98:99], v6 offset:8
  ds_read_b64 v[100:101], v6 offset:512
  ds_read_b64 v[102:103], v6 offset:520
  ds_read_b64 v[104:105], v6 offset:1024
  ds_read_b64 v[106:107], v6 offset:1032
  ds_read_b64 v[108:109], v6 offset:1536
  ds_read_b64 v[110:111], v6 offset:1544
  ds_read_b64 v[112:113], v6 offset:2048
  ds_read_b64 v[114:115], v6 offset:2056
  ds_read_b64 v[116:117], v6 offset:2560
  ds_read_b64 v[118:119], v6 offset:2568
  ds_read_b64 v[120:121], v6 offset:3072
  ds_read_b64 v[122:123], v6 offset:3080
  ds_read_b64 v[124:125], v6 offset:3584
  ds_read_b64 v[126:127], v6 offset:3592
  s_waitcnt lgkmcnt(0)
  v_mfma_f32_16x16x32_bf16 v[64:67], v[96:99], v[128:131], 0
  ds_read_b128 v[192:195], v7 offset:3648
  v_mfma_f32_16x16x32_bf16 v[68:71], v[96:99], v[132:135], 0
  ds_read_b128 v[196:199], v7 offset:3136
  v_mfma_f32_16x16x32_bf16 v[72:75], v[96:99], v[136:139], 0
  ds_read_b128 v[200:203], v7 offset:2624
  v_mfma_f32_16x16x32_bf16 v[76:79], v[96:99], v[140:143], 0
  ds_read_b128 v[204:207], v7 offset:2112
  v_mfma_f32_16x16x32_bf16 v[80:83], v[96:99], v[144:147], 0
  ds_read_b128 v[208:211], v7 offset:1600
  v_mfma_f32_16x16x32_bf16 v[84:87], v[96:99], v[148:151], 0
  ds_read_b128 v[212:215], v7 offset:1088
  v_mfma_f32_16x16x32_bf16 v[88:91], v[96:99], v[152:155], 0
  ds_read_b128 v[216:219], v7 offset:576
  v_mfma_f32_16x16x32_bf16 v[92:95], v[96:99], v[156:159], 0
  ds_read_b128 v[220:223], v7 offset:64
  v_mfma_f32_16x16x32_bf16 v[68:71], v[100:103], v[128:131], v[68:71]
  ds_read_b64 v[160:161], v6 offset:64
  v_mfma_f32_16x16x32_bf16 v[72:75], v[100:103], v[132:135], v[72:75]
  ds_read_b64 v[162:163], v6 offset:72
  v_mfma_f32_16x16x32_bf16 v[76:79], v[100:103], v[136:139], v[76:79]
  ds_read_b64 v[164:165], v6 offset:576
  v_mfma_f32_16x16x32_bf16 v[80:83], v[100:103], v[140:143], v[80:83]
  ds_read_b64 v[166:167], v6 offset:584
  v_mfma_f32_16x16x32_bf16 v[84:87], v[100:103], v[144:147], v[84:87]
  ds_read_b64 v[168:169], v6 offset:1088
  v_mfma_f32_16x16x32_bf16 v[88:91], v[100:103], v[148:151], v[88:91]
  ds_read_b64 v[170:171], v6 offset:1096
  v_mfma_f32_16x16x32_bf16 v[92:95], v[100:103], v[152:155], v[92:95]
  ds_read_b64 v[172:173], v6 offset:1600
  v_mfma_f32_16x16x32_bf16 v[72:75], v[104:107], v[128:131], v[72:75]
  ds_read_b64 v[174:175], v6 offset:1608
  v_mfma_f32_16x16x32_bf16 v[76:79], v[104:107], v[132:135], v[76:79]
  ds_read_b64 v[176:177], v6 offset:2112
  v_mfma_f32_16x16x32_bf16 v[80:83], v[104:107], v[136:139], v[80:83]
  ds_read_b64 v[178:179], v6 offset:2120
  v_mfma_f32_16x16x32_bf16 v[84:87], v[104:107], v[140:143], v[84:87]
  ds_read_b64 v[180:181], v6 offset:2624
  v_mfma_f32_16x16x32_bf16 v[88:91], v[104:107], v[144:147], v[88:91]
  ds_read_b64 v[182:183], v6 offset:2632
  v_mfma_f32_16x16x32_bf16 v[92:95], v[104:107], v[148:151], v[92:95]
  ds_read_b64 v[184:185], v6 offset:3136
  v_mfma_f32_16x16x32_bf16 v[76:79], v[108:111], v[128:131], v[76:79]
  ds_read_b64 v[186:187], v6 offset:3144
  v_mfma_f32_16x16x32_bf16 v[80:83], v[108:111], v[132:135], v[80:83]
  ds_read_b64 v[188:189], v6 offset:3648
  v_mfma_f32_16x16x32_bf16 v[84:87], v[108:111], v[136:139], v[84:87]
  ds_read_b64 v[190:191], v6 offset:3656
  v_mfma_f32_16x16x32_bf16 v[88:91], v[108:111], v[140:143], v[88:91]
  v_mfma_f32_16x16x32_bf16 v[92:95], v[108:111], v[144:147], v[92:95]
  v_mfma_f32_16x16x32_bf16 v[80:83], v[112:115], v[128:131], v[80:83]
  v_mfma_f32_16x16x32_bf16 v[84:87], v[112:115], v[132:135], v[84:87]
  v_mfma_f32_16x16x32_bf16 v[88:91], v[112:115], v[136:139], v[88:91]
  v_mfma_f32_16x16x32_bf16 v[92:95], v[112:115], v[140:143], v[92:95]
  v_mfma_f32_16x16x32_bf16 v[84:87], v[116:119], v[128:131], v[84:87]
  v_mfma_f32_16x16x32_bf16 v[88:91], v[116:119], v[132:135], v[88:91]
  v_mfma_f32_16x16x32_bf16 v[92:95], v[116:119], v[136:139], v[92:95]
  v_mfma_f32_16x16x32_bf16 v[88:91], v[120:123], v[128:131], v[88:91]
  v_mfma_f32_16x16x32_bf16 v[92:95], v[120:123], v[132:135], v[92:95]
  v_mfma_f32_16x16x32_bf16 v[92:95], v[124:127], v[128:131], v[92:95]
  s_waitcnt lgkmcnt(0)
  v_mfma_f32_16x16x32_bf16 v[64:67], v[160:163], v[192:195], v[64:67]
  ds_read_b128 v[128:131], v7 offset:3712
  v_mfma_f32_16x16x32_bf16 v[68:71], v[160:163], v[196:199], v[68:71]
  ds_read_b128 v[132:135], v7 offset:3200
  v_mfma_f32_16x16x32_bf16 v[72:75], v[160:163], v[200:203], v[72:75]
  ds_read_b128 v[136:139], v7 offset:2688
  v_mfma_f32_16x16x32_bf16 v[76:79], v[160:163], v[204:207], v[76:79]
  ds_read_b128 v[140:143], v7 offset:2176
  v_mfma_f32_16x16x32_bf16 v[80:83], v[160:163], v[208:211], v[80:83]
  ds_read_b128 v[144:147], v7 offset:1664
  v_mfma_f32_16x16x32_bf16 v[84:87], v[160:163], v[212:215], v[84:87]
  ds_read_b128 v[148:151], v7 offset:1152
  v_mfma_f32_16x16x32_bf16 v[88:91], v[160:163], v[216:219], v[88:91]
  ds_read_b128 v[152:155], v7 offset:640
  v_mfma_f32_16x16x32_bf16 v[92:95], v[160:163], v[220:223], v[92:95]
  ds_read_b128 v[156:159], v7 offset:128
  v_mfma_f32_16x16x32_bf16 v[68:71], v[164:167], v[192:195], v[68:71]
  ds_read_b64 v[96:97], v6 offset:128
  v_mfma_f32_16x16x32_bf16 v[72:75], v[164:167], v[196:199], v[72:75]
  ds_read_b64 v[98:99], v6 offset:136
  v_mfma_f32_16x16x32_bf16 v[76:79], v[164:167], v[200:203], v[76:79]
  ds_read_b64 v[100:101], v6 offset:640
  v_mfma_f32_16x16x32_bf16 v[80:83], v[164:167], v[204:207], v[80:83]
  ds_read_b64 v[102:103], v6 offset:648
  v_mfma_f32_16x16x32_bf16 v[84:87], v[164:167], v[208:211], v[84:87]
  ds_read_b64 v[104:105], v6 offset:1152
  v_mfma_f32_16x16x32_bf16 v[88:91], v[164:167], v[212:215], v[88:91]
  ds_read_b64 v[106:107], v6 offset:1160
  v_mfma_f32_16x16x32_bf16 v[92:95], v[164:167], v[216:219], v[92:95]
  ds_read_b64 v[108:109], v6 offset:1664
  v_mfma_f32_16x16x32_bf16 v[72:75], v[168:171], v[192:195], v[72:75]
  ds_read_b64 v[110:111], v6 offset:1672
  v_mfma_f32_16x16x32_bf16 v[76:79], v[168:171], v[196:199], v[76:79]
  ds_read_b64 v[112:113], v6 offset:2176
  v_mfma_f32_16x16x32_bf16 v[80:83], v[168:171], v[200:203], v[80:83]
  ds_read_b64 v[114:115], v6 offset:2184
  v_mfma_f32_16x16x32_bf16 v[84:87], v[168:171], v[204:207], v[84:87]
  ds_read_b64 v[116:117], v6 offset:2688
  v_mfma_f32_16x16x32_bf16 v[88:91], v[168:171], v[208:211], v[88:91]
  ds_read_b64 v[118:119], v6 offset:2696
  v_mfma_f32_16x16x32_bf16 v[92:95], v[168:171], v[212:215], v[92:95]
  ds_read_b64 v[120:121], v6 offset:3200
  v_mfma_f32_16x16x32_bf16 v[76:79], v[172:175], v[192:195], v[76:79]
  ds_read_b64 v[122:123], v6 offset:3208
  v_mfma_f32_16x16x32_bf16 v[80:83], v[172:175], v[196:199], v[80:83]
  ds_read_b64 v[124:125], v6 offset:3712
  v_mfma_f32_16x16x32_bf16 v[84:87], v[172:175], v[200:203], v[84:87]
  ds_read_b64 v[126:127], v6 offset:3720
  v_mfma_f32_16x16x32_bf16 v[88:91], v[172:175], v[204:207], v[88:91]
  v_mfma_f32_16x16x32_bf16 v[92:95], v[172:175], v[208:211], v[92:95]
  v_mfma_f32_16x16x32_bf16 v[80:83], v[176:179], v[192:195], v[80:83]
  v_mfma_f32_16x16x32_bf16 v[84:87], v[176:179], v[196:199], v[84:87]
  v_mfma_f32_16x16x32_bf16 v[88:91], v[176:179], v[200:203], v[88:91]
  v_mfma_f32_16x16x32_bf16 v[92:95], v[176:179], v[204:207], v[92:95]
  v_mfma_f32_16x16x32_bf16 v[84:87], v[180:183], v[192:195], v[84:87]
  v_mfma_f32_16x16x32_bf16 v[88:91], v[180:183], v[196:199], v[88:91]
  v_mfma_f32_16x16x32_bf16 v[92:95], v[180:183], v[200:203], v[92:95]
  v_mfma_f32_16x16x32_bf16 v[88:91], v[184:187], v[192:195], v[88:91]
  v_mfma_f32_16x16x32_bf16 v[92:95], v[184:187], v[196:199], v[92:95]
  v_mfma_f32_16x16x32_bf16 v[92:95], v[188:191], v[192:195], v[92:95]
  s_waitcnt lgkmcnt(0)
  v_mfma_f32_16x16x32_bf16 v[64:67], v[96:99], v[128:131], v[64:67]
  ds_read_b128 v[192:195], v7 offset:3776
  v_mfma_f32_16x16x32_bf16 v[68:71], v[96:99], v[132:135], v[68:71]
  ds_read_b128 v[196:199], v7 offset:3264
  v_mfma_f32_16x16x32_bf16 v[72:75], v[96:99], v[136:139], v[72:75]
  ds_read_b128 v[200:203], v7 offset:2752
  v_mfma_f32_16x16x32_bf16 v[76:79], v[96:99], v[140:143], v[76:79]
  ds_read_b128 v[204:207], v7 offset:2240
  v_mfma_f32_16x16x32_bf16 v[80:83], v[96:99], v[144:147], v[80:83]
  ds_read_b128 v[208:211], v7 offset:1728
  v_mfma_f32_16x16x32_bf16 v[84:87], v[96:99], v[148:151], v[84:87]
  ds_read_b128 v[212:215], v7 offset:1216
  v_mfma_f32_16x16x32_bf16 v[88:91], v[96:99], v[152:155], v[88:91]
  ds_read_b128 v[216:219], v7 offset:704
  v_mfma_f32_16x16x32_bf16 v[92:95], v[96:99], v[156:159], v[92:95]
  ds_read_b128 v[220:223], v7 offset:192
  v_mfma_f32_16x16x32_bf16 v[68:71], v[100:103], v[128:131], v[68:71]
  ds_read_b64 v[160:161], v6 offset:192
  v_mfma_f32_16x16x32_bf16 v[72:75], v[100:103], v[132:135], v[72:75]
  ds_read_b64 v[162:163], v6 offset:200
  v_mfma_f32_16x16x32_bf16 v[76:79], v[100:103], v[136:139], v[76:79]
  ds_read_b64 v[164:165], v6 offset:704
  v_mfma_f32_16x16x32_bf16 v[80:83], v[100:103], v[140:143], v[80:83]
  ds_read_b64 v[166:167], v6 offset:712
  v_mfma_f32_16x16x32_bf16 v[84:87], v[100:103], v[144:147], v[84:87]
  ds_read_b64 v[168:169], v6 offset:1216
  v_mfma_f32_16x16x32_bf16 v[88:91], v[100:103], v[148:151], v[88:91]
  ds_read_b64 v[170:171], v6 offset:1224
  v_mfma_f32_16x16x32_bf16 v[92:95], v[100:103], v[152:155], v[92:95]
  ds_read_b64 v[172:173], v6 offset:1728
  v_mfma_f32_16x16x32_bf16 v[72:75], v[104:107], v[128:131], v[72:75]
  ds_read_b64 v[174:175], v6 offset:1736
  v_mfma_f32_16x16x32_bf16 v[76:79], v[104:107], v[132:135], v[76:79]
  ds_read_b64 v[176:177], v6 offset:2240
  v_mfma_f32_16x16x32_bf16 v[80:83], v[104:107], v[136:139], v[80:83]
  ds_read_b64 v[178:179], v6 offset:2248
  v_mfma_f32_16x16x32_bf16 v[84:87], v[104:107], v[140:143], v[84:87]
  ds_read_b64 v[180:181], v6 offset:2752
  v_mfma_f32_16x16x32_bf16 v[88:91], v[104:107], v[144:147], v[88:91]
  ds_read_b64 v[182:183], v6 offset:2760
  v_mfma_f32_16x16x32_bf16 v[92:95], v[104:107], v[148:151], v[92:95]
  ds_read_b64 v[184:185], v6 offset:3264
  v_mfma_f32_16x16x32_bf16 v[76:79], v[108:111], v[128:131], v[76:79]
  ds_read_b64 v[186:187], v6 offset:3272
  v_mfma_f32_16x16x32_bf16 v[80:83], v[108:111], v[132:135], v[80:83]
  ds_read_b64 v[188:189], v6 offset:3776
  v_mfma_f32_16x16x32_bf16 v[84:87], v[108:111], v[136:139], v[84:87]
  ds_read_b64 v[190:191], v6 offset:3784
  v_mfma_f32_16x16x32_bf16 v[88:91], v[108:111], v[140:143], v[88:91]
  v_mfma_f32_16x16x32_bf16 v[92:95], v[108:111], v[144:147], v[92:95]
  v_mfma_f32_16x16x32_bf16 v[80:83], v[112:115], v[128:131], v[80:83]
  v_mfma_f32_16x16x32_bf16 v[84:87], v[112:115], v[132:135], v[84:87]
  v_mfma_f32_16x16x32_bf16 v[88:91], v[112:115], v[136:139], v[88:91]
  v_mfma_f32_16x16x32_bf16 v[92:95], v[112:115], v[140:143], v[92:95]
  v_mfma_f32_16x16x32_bf16 v[84:87], v[116:119], v[128:131], v[84:87]
  v_mfma_f32_16x16x32_bf16 v[88:91], v[116:119], v[132:135], v[88:91]
  v_mfma_f32_16x16x32_bf16 v[92:95], v[116:119], v[136:139], v[92:95]
  v_mfma_f32_16x16x32_bf16 v[88:91], v[120:123], v[128:131], v[88:91]
  v_mfma_f32_16x16x32_bf16 v[92:95], v[120:123], v[132:135], v[92:95]
  v_mfma_f32_16x16x32_bf16 v[92:95], v[124:127], v[128:131], v[92:95]
  s_waitcnt lgkmcnt(0)
  v_mfma_f32_16x16x32_bf16 v[64:67], v[160:163], v[192:195], v[64:67]
  v_mfma_f32_16x16x32_bf16 v[68:71], v[160:163], v[196:199], v[68:71]
  v_mfma_f32_16x16x32_bf16 v[72:75], v[160:163], v[200:203], v[72:75]
  v_mfma_f32_16x16x32_bf16 v[76:79], v[160:163], v[204:207], v[76:79]
  v_mfma_f32_16x16x32_bf16 v[80:83], v[160:163], v[208:211], v[80:83]
  v_mfma_f32_16x16x32_bf16 v[84:87], v[160:163], v[212:215], v[84:87]
  v_mfma_f32_16x16x32_bf16 v[88:91], v[160:163], v[216:219], v[88:91]
  v_mfma_f32_16x16x32_bf16 v[92:95], v[160:163], v[220:223], v[92:95]
  v_mfma_f32_16x16x32_bf16 v[68:71], v[164:167], v[192:195], v[68:71]
  v_mfma_f32_16x16x32_bf16 v[72:75], v[164:167], v[196:199], v[72:75]
  v_mfma_f32_16x16x32_bf16 v[76:79], v[164:167], v[200:203], v[76:79]
  v_mfma_f32_16x16x32_bf16 v[80:83], v[164:167], v[204:207], v[80:83]
  v_mfma_f32_16x16x32_bf16 v[84:87], v[164:167], v[208:211], v[84:87]
  v_mfma_f32_16x16x32_bf16 v[88:91], v[164:167], v[212:215], v[88:91]
  v_mfma_f32_16x16x32_bf16 v[92:95], v[164:167], v[216:219], v[92:95]
  v_mfma_f32_16x16x32_bf16 v[72:75], v[168:171], v[192:195], v[72:75]
  v_mfma_f32_16x16x32_bf16 v[76:79], v[168:171], v[196:199], v[76:79]
  v_mfma_f32_16x16x32_bf16 v[80:83], v[168:171], v[200:203], v[80:83]
  v_mfma_f32_16x16x32_bf16 v[84:87], v[168:171], v[204:207], v[84:87]
  v_mfma_f32_16x16x32_bf16 v[88:91], v[168:171], v[208:211], v[88:91]
  v_mfma_f32_16x16x32_bf16 v[92:95], v[168:171], v[212:215], v[92:95]
  v_mfma_f32_16x16x32_bf16 v[76:79], v[172:175], v[192:195], v[76:79]
  v_mfma_f32_16x16x32_bf16 v[80:83], v[172:175], v[196:199], v[80:83]
  v_mfma_f32_16x16x32_bf16 v[84:87], v[172:175], v[200:203], v[84:87]
  v_mfma_f32_16x16x32_bf16 v[88:91], v[172:175], v[204:207], v[88:91]
  v_mfma_f32_16x16x32_bf16 v[92:95], v[172:175], v[208:211], v[92:95]
  v_mfma_f32_16x16x32_bf16 v[80:83], v[176:179], v[192:195], v[80:83]
  v_mfma_f32_16x16x32_bf16 v[84:87], v[176:179], v[196:199], v[84:87]
  v_mfma_f32_16x16x32_bf16 v[88:91], v[176:179], v[200:203], v[88:91]
  v_mfma_f32_16x16x32_bf16 v[92:95], v[176:179], v[204:207], v[92:95]
  v_mfma_f32_16x16x32_bf16 v[84:87], v[180:183], v[192:195], v[84:87]
  v_mfma_f32_16x16x32_bf16 v[88:91], v[180:183], v[196:199], v[88:91]
  v_mfma_f32_16x16x32_bf16 v[92:95], v[180:183], v[200:203], v[92:95]
  v_mfma_f32_16x16x32_bf16 v[88:91], v[184:187], v[192:195], v[88:91]
  v_mfma_f32_16x16x32_bf16 v[92:95], v[184:187], v[196:199], v[92:95]
  v_mfma_f32_16x16x32_bf16 v[92:95], v[188:191], v[192:195], v[92:95]
  s_lshl_b32 s66, s60, 13
  s_add_u32 s66, s66, 42496
  v_lshlrev_b32 v8, 4, v1
  v_add_u32 v8, s66, v8
  s_nop 7
  ds_write_b128 v8, v[64:67] offset:0
  ds_write_b128 v8, v[68:71] offset:1024
  ds_write_b128 v8, v[72:75] offset:2048
  ds_write_b128 v8, v[76:79] offset:3072
  ds_write_b128 v8, v[80:83] offset:4096
  ds_write_b128 v8, v[84:87] offset:5120
  ds_write_b128 v8, v[88:91] offset:6144
  ds_write_b128 v8, v[92:95] offset:7168
  s_waitcnt vmcnt(2)
  s_waitcnt lgkmcnt(0)
  s_branch L_RED
L_GB:
  v_subrev_u32 v9, 256, v0
  v_and_b32 v2, 15, v9
  v_lshrrev_b32 v3, 4, v9
  s_lshl_b32 s66, s63, 16
  s_lshl_b32 s67, s62, 7
  s_add_u32 s66, s66, s67
  v_lshlrev_b32 v4, 12, v3
  v_lshl_add_u32 v4, v2, 3, v4
  v_add_u32 v4, s66, v4
  v_add_u32 v56, 4294964224, v4
  v_add_u32 v57, 4294965248, v4
  v_add_u32 v58, 4294966272, v4
  v_add_u32 v59, 0, v4
  v_add_u32 v60, 1024, v4
  v_add_u32 v61, 2048, v4
  v_add_u32 v62, 3072, v4
  buffer_load_dwordx2 v[26:27], v56, s[32:35], 0 offen
  buffer_load_dwordx2 v[28:29], v57, s[32:35], 0 offen
  buffer_load_dwordx2 v[30:31], v58, s[32:35], 0 offen
  buffer_load_dwordx2 v[32:33], v59, s[32:35], 0 offen
  buffer_load_dwordx2 v[34:35], v60, s[32:35], 0 offen
  buffer_load_dwordx2 v[36:37], v61, s[32:35], 0 offen
  buffer_load_dwordx2 v[38:39], v62, s[32:35], 0 offen
  buffer_load_dwordx2 v[40:41], v4, s[36:39], 0 offen offset:0
  buffer_load_dwordx2 v[42:43], v4, s[36:39], 0 offen offset:1024
  buffer_load_dwordx2 v[44:45], v4, s[36:39], 0 offen offset:2048
  buffer_load_dwordx2 v[46:47], v4, s[36:39], 0 offen offset:3072
  v_lshlrev_b32 v5, 5, v2
  s_lshl_b32 s67, s62, 9
  v_add_u32 v5, s67, v5
  buffer_load_dwordx4 v[48:51], v5, s[40:43], 0 offen
  buffer_load_dwordx4 v[52:55], v5, s[40:43], 0 offen offset:16
  s_sub_u32 s70, s60, 4
  s_and_b32 s77, s70, 1
  s_mul_i32 s77, s77, 7
  s_lshl_b32 s72, s77, 6
  s_lshl_b32 s77, s77, 10
  s_cmp_ge_u32 s70, 2
  s_cselect_b32 s56, s16, s12
  s_cselect_b32 s57, s17, s13
  s_mov_b32 s58, 1835008
  s_mov_b32 s59, 0x20000
  s_mov_b32 s66, 16384
  s_cselect_b32 s66, 30848, s66
  s_add_u32 s77, s77, s66
  v_add_u32 v2, s72, v1
  v_add_u32 v2, 0, v2
  v_mul_u32_u24 v3, 4682, v2
  v_lshrrev_b32 v3, 16, v3
  v_mul_u32_u24 v4, 14, v3
  v_sub_u32 v4, v2, v4
  v_mul_u32_u24 v3, 3584, v3
  v_lshl_add_u32 v10, v4, 4, v3
  s_mul_i32 s69, s65, 224
  v_add_u32 v10, s69, v10
  v_add_u32 v2, s72, v1
  v_add_u32 v2, 64, v2
  v_mul_u32_u24 v3, 4682, v2
  v_lshrrev_b32 v3, 16, v3
  v_mul_u32_u24 v4, 14, v3
  v_sub_u32 v4, v2, v4
  v_mul_u32_u24 v3, 3584, v3
  v_lshl_add_u32 v11, v4, 4, v3
  s_mul_i32 s69, s65, 224
  v_add_u32 v11, s69, v11
  v_add_u32 v2, s72, v1
  v_add_u32 v2, 128, v2
  v_mul_u32_u24 v3, 4682, v2
  v_lshrrev_b32 v3, 16, v3
  v_mul_u32_u24 v4, 14, v3
  v_sub_u32 v4, v2, v4
  v_mul_u32_u24 v3, 3584, v3
  v_lshl_add_u32 v12, v4, 4, v3
  s_mul_i32 s69, s65, 224
  v_add_u32 v12, s69, v12
  v_add_u32 v2, s72, v1
  v_add_u32 v2, 192, v2
  v_mul_u32_u24 v3, 4682, v2
  v_lshrrev_b32 v3, 16, v3
  v_mul_u32_u24 v4, 14, v3
  v_sub_u32 v4, v2, v4
  v_mul_u32_u24 v3, 3584, v3
  v_lshl_add_u32 v13, v4, 4, v3
  s_mul_i32 s69, s65, 224
  v_add_u32 v13, s69, v13
  v_add_u32 v2, s72, v1
  v_add_u32 v2, 256, v2
  v_mul_u32_u24 v3, 4682, v2
  v_lshrrev_b32 v3, 16, v3
  v_mul_u32_u24 v4, 14, v3
  v_sub_u32 v4, v2, v4
  v_mul_u32_u24 v3, 3584, v3
  v_lshl_add_u32 v14, v4, 4, v3
  s_mul_i32 s69, s65, 224
  v_add_u32 v14, s69, v14
  v_add_u32 v2, s72, v1
  v_add_u32 v2, 320, v2
  v_mul_u32_u24 v3, 4682, v2
  v_lshrrev_b32 v3, 16, v3
  v_mul_u32_u24 v4, 14, v3
  v_sub_u32 v4, v2, v4
  v_mul_u32_u24 v3, 3584, v3
  v_lshl_add_u32 v15, v4, 4, v3
  s_mul_i32 s69, s65, 224
  v_add_u32 v15, s69, v15
  v_add_u32 v2, s72, v1
  v_add_u32 v2, 384, v2
  v_mul_u32_u24 v3, 4682, v2
  v_lshrrev_b32 v3, 16, v3
  v_mul_u32_u24 v4, 14, v3
  v_sub_u32 v4, v2, v4
  v_mul_u32_u24 v3, 3584, v3
  v_lshl_add_u32 v16, v4, 4, v3
  s_mul_i32 s69, s65, 224
  v_add_u32 v16, s69, v16
  s_lshr_b32 s66, s62, 2
  s_lshl_b32 s66, s66, 10
  s_lshl_b32 s67, s63, 5
  s_add_u32 s66, s66, s67
  v_add_u32 v2, s66, v1
  v_lshlrev_b32 v2, 10, v2
  s_mul_i32 s66, s63, 28
  v_subrev_u32 v3, 32, v1
  v_min_u32 v3, 27, v3
  v_add_u32 v3, s66, v3
  v_cmp_le_u32 vcc, 448, v3
  v_subrev_u32 v4, 448, v3
  s_mov_b64 s[68:69], vcc
  s_nop 0
  v_cndmask_b32 v3, v3, v4, s[68:69]
  v_mul_u32_u24 v4, 9363, v3
  v_lshrrev_b32 v4, 16, v4
  v_mul_u32_u24 v5, 7, v4
  v_sub_u32 v5, v3, v5
  v_mul_u32_u24 v4, 3584, v4
  v_lshl_add_u32 v4, v5, 7, v4
  s_and_b32 s66, s62, 3
  s_mul_i32 s66, s66, 896
  v_add_u32 v4, s66, v4
  v_mov_b32 v5, s12
  v_mov_b32 v6, s13
  v_mov_b32 v7, s16
  v_mov_b32 v8, s17
  v_cndmask_b32 v5, v5, v7, s[68:69]
  v_cndmask_b32 v6, v6, v8, s[68:69]
  v_mov_b32 v7, s8
  v_mov_b32 v8, s9
  v_mov_b32 v152, 229376
  v_mov_b32 v3, 128
  v_cmp_gt_u32 vcc, 32, v1
  s_nop 1
  v_cndmask_b32 v4, v4, v2, vcc
  v_cndmask_b32 v5, v5, v7, vcc
  v_cndmask_b32 v6, v6, v8, vcc
  v_cndmask_b32 v152, v152, v3, vcc
  v_add_co_u32 v150, vcc, v5, v4
  s_nop 1
  v_addc_co_u32 v151, vcc, 0, v6, vcc
  s_barrier
  s_mov_b32 s76, 0
  s_add_u32 m0, s77, 0
  s_nop 0
  buffer_load_dwordx4 v10, s[56:59], s76 offen lds
  s_add_u32 m0, s77, 1024
  s_nop 0
  buffer_load_dwordx4 v11, s[56:59], s76 offen lds
  s_add_u32 m0, s77, 2048
  s_nop 0
  buffer_load_dwordx4 v12, s[56:59], s76 offen lds
  s_add_u32 m0, s77, 3072
  s_nop 0
  buffer_load_dwordx4 v13, s[56:59], s76 offen lds
  s_add_u32 m0, s77, 4096
  s_nop 0
  buffer_load_dwordx4 v14, s[56:59], s76 offen lds
  s_add_u32 m0, s77, 5120
  s_nop 0
  buffer_load_dwordx4 v15, s[56:59], s76 offen lds
  s_add_u32 m0, s77, 6144
  s_nop 0
  buffer_load_dwordx4 v16, s[56:59], s76 offen lds
  s_mov_b32 s76, 229376
  s_add_u32 m0, s77, 45184
  s_nop 0
  buffer_load_dwordx4 v10, s[56:59], s76 offen lds
  s_add_u32 m0, s77, 46208
  s_nop 0
  buffer_load_dwordx4 v11, s[56:59], s76 offen lds
  s_add_u32 m0, s77, 47232
  s_nop 0
  buffer_load_dwordx4 v12, s[56:59], s76 offen lds
  s_add_u32 m0, s77, 48256
  s_nop 0
  buffer_load_dwordx4 v13, s[56:59], s76 offen lds
  s_add_u32 m0, s77, 49280
  s_nop 0
  buffer_load_dwordx4 v14, s[56:59], s76 offen lds
  s_add_u32 m0, s77, 50304
  s_nop 0
  buffer_load_dwordx4 v15, s[56:59], s76 offen lds
  s_add_u32 m0, s77, 51328
  s_nop 0
  buffer_load_dwordx4 v16, s[56:59], s76 offen lds
  s_add_u32 s71, s70, 4
  v_mad_u64_u32 v[154:155], s[68:69], v152, s71, v[150:151]
  s_nop 0
  global_load_dword v254, v[154:155], off
  s_waitcnt vmcnt(15)
  v_lshlrev_b32 v64, 16, v26
  v_and_b32 v65, 0xffff0000, v26
  v_lshlrev_b32 v66, 16, v27
  v_and_b32 v67, 0xffff0000, v27
  v_lshlrev_b32 v68, 16, v28
  v_and_b32 v69, 0xffff0000, v28
  v_lshlrev_b32 v70, 16, v29
  v_and_b32 v71, 0xffff0000, v29
  v_lshlrev_b32 v72, 16, v30
  v_and_b32 v73, 0xffff0000, v30
  v_lshlrev_b32 v74, 16, v31
  v_and_b32 v75, 0xffff0000, v31
  v_lshlrev_b32 v76, 16, v32
  v_and_b32 v77, 0xffff0000, v32
  v_lshlrev_b32 v78, 16, v33
  v_and_b32 v79, 0xffff0000, v33
  v_lshlrev_b32 v80, 16, v34
  v_and_b32 v81, 0xffff0000, v34
  v_lshlrev_b32 v82, 16, v35
  v_and_b32 v83, 0xffff0000, v35
  v_lshlrev_b32 v84, 16, v36
  v_and_b32 v85, 0xffff0000, v36
  v_lshlrev_b32 v86, 16, v37
  v_and_b32 v87, 0xffff0000, v37
  v_lshlrev_b32 v88, 16, v38
  v_and_b32 v89, 0xffff0000, v38
  v_lshlrev_b32 v90, 16, v39
  v_and_b32 v91, 0xffff0000, v39
  v_lshlrev_b32 v92, 16, v40
  v_and_b32 v93, 0xffff0000, v40
  v_lshlrev_b32 v94, 16, v41
  v_and_b32 v95, 0xffff0000, v41
  v_lshlrev_b32 v96, 16, v42
  v_and_b32 v97, 0xffff0000, v42
  v_lshlrev_b32 v98, 16, v43
  v_and_b32 v99, 0xffff0000, v43
  v_lshlrev_b32 v100, 16, v44
  v_and_b32 v101, 0xffff0000, v44
  v_lshlrev_b32 v102, 16, v45
  v_and_b32 v103, 0xffff0000, v45
  v_lshlrev_b32 v104, 16, v46
  v_and_b32 v105, 0xffff0000, v46
  v_lshlrev_b32 v106, 16, v47
  v_and_b32 v107, 0xffff0000, v47
  v_lshlrev_b32 v108, 16, v48
  v_and_b32 v112, 0xffff0000, v48
  v_lshlrev_b32 v116, 16, v49
  v_and_b32 v120, 0xffff0000, v49
  v_lshlrev_b32 v109, 16, v50
  v_and_b32 v113, 0xffff0000, v50
  v_lshlrev_b32 v117, 16, v51
  v_and_b32 v121, 0xffff0000, v51
  v_lshlrev_b32 v110, 16, v52
  v_and_b32 v114, 0xffff0000, v52
  v_lshlrev_b32 v118, 16, v53
  v_and_b32 v122, 0xffff0000, v53
  v_lshlrev_b32 v111, 16, v54
  v_and_b32 v115, 0xffff0000, v54
  v_lshlrev_b32 v119, 16, v55
  v_and_b32 v123, 0xffff0000, v55
  v_pk_mul_f32 v[124:125], v[64:65], v[120:121]
  v_pk_fma_f32 v[124:125], v[68:69], v[116:117], v[124:125]
  v_pk_fma_f32 v[124:125], v[72:73], v[112:113], v[124:125]
  v_pk_fma_f32 v[124:125], v[76:77], v[108:109], v[124:125]
  v_cvt_pk_bf16_f32 v140, v124, v125
  v_lshlrev_b32 v124, 16, v140
  v_and_b32 v125, 0xffff0000, v140
  v_pk_mul_f32 v[124:125], v[124:125], v[92:93]
  v_pk_mul_f32 v[126:127], v[66:67], v[122:123]
  v_pk_fma_f32 v[126:127], v[70:71], v[118:119], v[126:127]
  v_pk_fma_f32 v[126:127], v[74:75], v[114:115], v[126:127]
  v_pk_fma_f32 v[126:127], v[78:79], v[110:111], v[126:127]
  v_cvt_pk_bf16_f32 v140, v126, v127
  v_lshlrev_b32 v126, 16, v140
  v_and_b32 v127, 0xffff0000, v140
  v_pk_mul_f32 v[126:127], v[126:127], v[94:95]
  v_pk_mul_f32 v[128:129], v[68:69], v[120:121]
  v_pk_fma_f32 v[128:129], v[72:73], v[116:117], v[128:129]
  v_pk_fma_f32 v[128:129], v[76:77], v[112:113], v[128:129]
  v_pk_fma_f32 v[128:129], v[80:81], v[108:109], v[128:129]
  v_cvt_pk_bf16_f32 v140, v128, v129
  v_lshlrev_b32 v128, 16, v140
  v_and_b32 v129, 0xffff0000, v140
  v_pk_mul_f32 v[128:129], v[128:129], v[96:97]
  v_pk_mul_f32 v[130:131], v[70:71], v[122:123]
  v_pk_fma_f32 v[130:131], v[74:75], v[118:119], v[130:131]
  v_pk_fma_f32 v[130:131], v[78:79], v[114:115], v[130:131]
  v_pk_fma_f32 v[130:131], v[82:83], v[110:111], v[130:131]
  v_cvt_pk_bf16_f32 v140, v130, v131
  v_lshlrev_b32 v130, 16, v140
  v_and_b32 v131, 0xffff0000, v140
  v_pk_mul_f32 v[130:131], v[130:131], v[98:99]
  v_pk_mul_f32 v[132:133], v[72:73], v[120:121]
  v_pk_fma_f32 v[132:133], v[76:77], v[116:117], v[132:133]
  v_pk_fma_f32 v[132:133], v[80:81], v[112:113], v[132:133]
  v_pk_fma_f32 v[132:133], v[84:85], v[108:109], v[132:133]
  v_cvt_pk_bf16_f32 v140, v132, v133
  v_lshlrev_b32 v132, 16, v140
  v_and_b32 v133, 0xffff0000, v140
  v_pk_mul_f32 v[132:133], v[132:133], v[100:101]
  v_pk_mul_f32 v[134:135], v[74:75], v[122:123]
  v_pk_fma_f32 v[134:135], v[78:79], v[118:119], v[134:135]
  v_pk_fma_f32 v[134:135], v[82:83], v[114:115], v[134:135]
  v_pk_fma_f32 v[134:135], v[86:87], v[110:111], v[134:135]
  v_cvt_pk_bf16_f32 v140, v134, v135
  v_lshlrev_b32 v134, 16, v140
  v_and_b32 v135, 0xffff0000, v140
  v_pk_mul_f32 v[134:135], v[134:135], v[102:103]
  v_pk_mul_f32 v[136:137], v[76:77], v[120:121]
  v_pk_fma_f32 v[136:137], v[80:81], v[116:117], v[136:137]
  v_pk_fma_f32 v[136:137], v[84:85], v[112:113], v[136:137]
  v_pk_fma_f32 v[136:137], v[88:89], v[108:109], v[136:137]
  v_cvt_pk_bf16_f32 v140, v136, v137
  v_lshlrev_b32 v136, 16, v140
  v_and_b32 v137, 0xffff0000, v140
  v_pk_mul_f32 v[136:137], v[136:137], v[104:105]
  v_pk_mul_f32 v[138:139], v[78:79], v[122:123]
  v_pk_fma_f32 v[138:139], v[82:83], v[118:119], v[138:139]
  v_pk_fma_f32 v[138:139], v[86:87], v[114:115], v[138:139]
  v_pk_fma_f32 v[138:139], v[90:91], v[110:111], v[138:139]
  v_cvt_pk_bf16_f32 v140, v138, v139
  v_lshlrev_b32 v138, 16, v140
  v_and_b32 v139, 0xffff0000, v140
  v_pk_mul_f32 v[138:139], v[138:139], v[106:107]
  v_subrev_u32 v9, 256, v0
  v_and_b32 v2, 15, v9
  v_lshrrev_b32 v3, 4, v9
  v_mul_u32_u24 v7, 544, v2
  v_lshlrev_b32 v3, 3, v3
  v_sub_u32 v3, 120, v3
  v_add_u32 v7, v7, v3
  v_add_u32 v8, 135552, v7
  v_cvt_pk_bf16_f32 v142, v136, v132
  v_cvt_pk_bf16_f32 v143, v128, v124
  ds_write_b64 v8, v[142:143] offset:0
  v_cvt_pk_bf16_f32 v144, v137, v133
  v_cvt_pk_bf16_f32 v145, v129, v125
  ds_write_b64 v8, v[144:145] offset:136
  v_cvt_pk_bf16_f32 v146, v138, v134
  v_cvt_pk_bf16_f32 v147, v130, v126
  ds_write_b64 v8, v[146:147] offset:272
  v_cvt_pk_bf16_f32 v148, v139, v135
  v_cvt_pk_bf16_f32 v149, v131, v127
  ds_write_b64 v8, v[148:149] offset:408
  s_waitcnt lgkmcnt(0)
  s_waitcnt lgkmcnt(0)
  s_add_u32 s61, s61, 1
  s_waitcnt vmcnt(8)
  s_barrier
  s_mov_b32 s76, 458752
  s_add_u32 m0, s77, 90368
  s_nop 0
  buffer_load_dwordx4 v10, s[56:59], s76 offen lds
  s_add_u32 m0, s77, 91392
  s_nop 0
  buffer_load_dwordx4 v11, s[56:59], s76 offen lds
  s_add_u32 m0, s77, 92416
  s_nop 0
  buffer_load_dwordx4 v12, s[56:59], s76 offen lds
  s_add_u32 m0, s77, 93440
  s_nop 0
  buffer_load_dwordx4 v13, s[56:59], s76 offen lds
  s_add_u32 m0, s77, 94464
  s_nop 0
  buffer_load_dwordx4 v14, s[56:59], s76 offen lds
  s_add_u32 m0, s77, 95488
  s_nop 0
  buffer_load_dwordx4 v15, s[56:59], s76 offen lds
  s_add_u32 m0, s77, 96512
  s_nop 0
  buffer_load_dwordx4 v16, s[56:59], s76 offen lds
  v_subrev_u32 v9, 256, v0
  v_lshrrev_b32 v2, 2, v9
  v_and_b32 v3, 3, v9
  v_mul_u32_u24 v7, 136, v2
  v_lshl_add_u32 v7, v3, 4, v7
  v_add_u32 v7, 135552, v7
  ds_read_b64 v[64:65], v7
  ds_read_b64 v[66:67], v7 offset:8
  ds_read_b64 v[68:69], v7 offset:64
  ds_read_b64 v[70:71], v7 offset:72
  v_lshlrev_b32 v8, 12, v2
  v_lshl_add_u32 v8, v3, 4, v8
  s_lshl_b32 s66, s62, 18
  s_lshl_b32 s67, s63, 7
  s_sub_u32 s66, s66, s67
  s_add_u32 s66, s66, 69504
  s_waitcnt lgkmcnt(0)
  buffer_store_dwordx4 v[64:67], v8, s[4:7], s66 offen sc1
  buffer_store_dwordx4 v[68:71], v8, s[4:7], s66 offen offset:64 sc1
  s_waitcnt vmcnt(10)
  s_barrier
  s_mov_b32 s76, 688128
  s_add_u32 m0, s77, 0
  s_nop 0
  buffer_load_dwordx4 v10, s[56:59], s76 offen lds
  s_add_u32 m0, s77, 1024
  s_nop 0
  buffer_load_dwordx4 v11, s[56:59], s76 offen lds
  s_add_u32 m0, s77, 2048
  s_nop 0
  buffer_load_dwordx4 v12, s[56:59], s76 offen lds
  s_add_u32 m0, s77, 3072
  s_nop 0
  buffer_load_dwordx4 v13, s[56:59], s76 offen lds
  s_add_u32 m0, s77, 4096
  s_nop 0
  buffer_load_dwordx4 v14, s[56:59], s76 offen lds
  s_add_u32 m0, s77, 5120
  s_nop 0
  buffer_load_dwordx4 v15, s[56:59], s76 offen lds
  s_add_u32 m0, s77, 6144
  s_nop 0
  buffer_load_dwordx4 v16, s[56:59], s76 offen lds
  s_waitcnt vmcnt(9)
  s_barrier
  s_mov_b32 s76, 917504
  s_add_u32 m0, s77, 45184
  s_nop 0
  buffer_load_dwordx4 v10, s[56:59], s76 offen lds
  s_add_u32 m0, s77, 46208
  s_nop 0
  buffer_load_dwordx4 v11, s[56:59], s76 offen lds
  s_add_u32 m0, s77, 47232
  s_nop 0
  buffer_load_dwordx4 v12, s[56:59], s76 offen lds
  s_add_u32 m0, s77, 48256
  s_nop 0
  buffer_load_dwordx4 v13, s[56:59], s76 offen lds
  s_add_u32 m0, s77, 49280
  s_nop 0
  buffer_load_dwordx4 v14, s[56:59], s76 offen lds
  s_add_u32 m0, s77, 50304
  s_nop 0
  buffer_load_dwordx4 v15, s[56:59], s76 offen lds
  s_add_u32 m0, s77, 51328
  s_nop 0
  buffer_load_dwordx4 v16, s[56:59], s76 offen lds
  s_waitcnt vmcnt(7)
  s_barrier
  s_cmp_eq_u32 s60, 4
  s_cbranch_scc0 FL_5
  s_lshl_b32 s66, s62, 5
  s_add_u32 s66, s66, s63
  s_lshl_b32 s66, s66, 2
  s_add_u32 s66, s66, 0
  v_mov_b32 v2, s61
  v_mov_b32 v9, 0
  s_mov_b64 exec, 1
  buffer_store_dword v2, v9, s[4:7], s66 offen sc1
  s_mov_b64 exec, -1
FL_5:
  s_mov_b32 s76, 1146880
  s_add_u32 m0, s77, 90368
  s_nop 0
  buffer_load_dwordx4 v10, s[56:59], s76 offen lds
  s_add_u32 m0, s77, 91392
  s_nop 0
  buffer_load_dwordx4 v11, s[56:59], s76 offen lds
  s_add_u32 m0, s77, 92416
  s_nop 0
  buffer_load_dwordx4 v12, s[56:59], s76 offen lds
  s_add_u32 m0, s77, 93440
  s_nop 0
  buffer_load_dwordx4 v13, s[56:59], s76 offen lds
  s_add_u32 m0, s77, 94464
  s_nop 0
  buffer_load_dwordx4 v14, s[56:59], s76 offen lds
  s_add_u32 m0, s77, 95488
  s_nop 0
  buffer_load_dwordx4 v15, s[56:59], s76 offen lds
  s_add_u32 m0, s77, 96512
  s_nop 0
  buffer_load_dwordx4 v16, s[56:59], s76 offen lds
  s_waitcnt vmcnt(7)
  s_barrier
  s_mov_b32 s76, 1376256
  s_add_u32 m0, s77, 0
  s_nop 0
  buffer_load_dwordx4 v10, s[56:59], s76 offen lds
  s_add_u32 m0, s77, 1024
  s_nop 0
  buffer_load_dwordx4 v11, s[56:59], s76 offen lds
  s_add_u32 m0, s77, 2048
  s_nop 0
  buffer_load_dwordx4 v12, s[56:59], s76 offen lds
  s_add_u32 m0, s77, 3072
  s_nop 0
  buffer_load_dwordx4 v13, s[56:59], s76 offen lds
  s_add_u32 m0, s77, 4096
  s_nop 0
  buffer_load_dwordx4 v14, s[56:59], s76 offen lds
  s_add_u32 m0, s77, 5120
  s_nop 0
  buffer_load_dwordx4 v15, s[56:59], s76 offen lds
  s_add_u32 m0, s77, 6144
  s_nop 0
  buffer_load_dwordx4 v16, s[56:59], s76 offen lds
  s_cmp_eq_u32 s60, 7
  s_cbranch_scc0 SK_6
  v_lshlrev_b32 v3, 7, v1
  s_lshl_b32 s66, s2, 13
  buffer_load_dword v254, v3, s[52:55], s66 offen
SK_6:
  s_waitcnt vmcnt(7)
  s_barrier
  s_mov_b32 s76, 1605632
  s_add_u32 m0, s77, 45184
  s_nop 0
  buffer_load_dwordx4 v10, s[56:59], s76 offen lds
  s_add_u32 m0, s77, 46208
  s_nop 0
  buffer_load_dwordx4 v11, s[56:59], s76 offen lds
  s_add_u32 m0, s77, 47232
  s_nop 0
  buffer_load_dwordx4 v12, s[56:59], s76 offen lds
  s_add_u32 m0, s77, 48256
  s_nop 0
  buffer_load_dwordx4 v13, s[56:59], s76 offen lds
  s_add_u32 m0, s77, 49280
  s_nop 0
  buffer_load_dwordx4 v14, s[56:59], s76 offen lds
  s_add_u32 m0, s77, 50304
  s_nop 0
  buffer_load_dwordx4 v15, s[56:59], s76 offen lds
  s_add_u32 m0, s77, 51328
  s_nop 0
  buffer_load_dwordx4 v16, s[56:59], s76 offen lds
  s_waitcnt vmcnt(7)
  s_barrier
  s_lshr_b32 s66, s2, 5
  s_lshl_b32 s66, s66, 7
  s_add_u32 s66, s66, 0
  v_and_b32 v29, 31, v1
  v_lshlrev_b32 v29, 2, v29
  v_add_u32 v29, s66, v29
  buffer_load_dword v28, v29, s[4:7], 0 offen sc1
  s_waitcnt vmcnt(1)
  s_barrier
  s_waitcnt vmcnt(0)
  v_cmp_ne_u32 vcc, s61, v28
  s_cbranch_vccz F1OK_7
  s_mov_b32 s95, 0x40000
POLL_8:
  buffer_load_dword v28, v29, s[4:7], 0 offen sc1
  s_waitcnt vmcnt(0)
  v_cmp_ne_u32 vcc, s61, v28
  s_cbranch_vccz POLLD_9
  s_sub_u32 s95, s95, 1
  s_cmp_eq_u32 s95, 0
  s_cbranch_scc1 POLLD_9
  s_branch POLL_8
POLLD_9:
F1OK_7:
  v_subrev_u32 v3, 256, v0
  s_lshl_b32 s66, s2, 13
  s_add_u32 s66, s66, 65536
  v_lshlrev_b32 v30, 4, v3
  buffer_load_dwordx4 v[202:205], v30, s[4:7], s66 offen sc1
  s_add_u32 s66, s66, 4096
  buffer_load_dwordx4 v[206:209], v30, s[4:7], s66 offen sc1
  v_subrev_u32 v3, 256, v0
  s_lshl_b32 s66, s2, 13
  v_lshlrev_b32 v26, 4, v3
  v_add_u32 v26, s66, v26
  buffer_load_dwordx4 v[170:173], v26, s[52:55], 0 offen offset:0
  buffer_load_dwordx4 v[174:177], v26, s[52:55], 0 offen offset:2
  buffer_load_dwordx4 v[178:181], v26, s[52:55], 0 offen offset:4
  buffer_load_dwordx4 v[182:185], v26, s[52:55], 0 offen offset:6
  v_add_u32 v27, 4096, v26
  buffer_load_dwordx4 v[186:189], v27, s[52:55], 0 offen offset:0
  buffer_load_dwordx4 v[190:193], v27, s[52:55], 0 offen offset:2
  buffer_load_dwordx4 v[194:197], v27, s[52:55], 0 offen offset:4
  buffer_load_dwordx4 v[198:201], v27, s[52:55], 0 offen offset:6
  s_lshl_b32 s66, s64, 7
  s_lshl_b32 s67, s65, 3
  s_add_u32 s66, s66, s67
  s_lshl_b32 s67, s70, 1
  s_add_u32 s71, s66, s67
  s_lshl_b32 s66, s71, 10
  v_lshlrev_b32 v6, 4, v1
  buffer_load_dwordx4 v[212:215], v6, s[24:27], s66 offen
  buffer_load_dwordx4 v[216:219], v6, s[24:27], s66 offen offset:1024
  buffer_load_dwordx4 v[220:223], v6, s[44:47], 0 offen
  s_lshl_b32 s66, s2, 2
  v_mov_b32 v5, s66
  buffer_load_dword v250, v5, s[48:51], 0 offen
  s_waitcnt vmcnt(12)
  v_subrev_u32 v3, 256, v0
  v_lshlrev_b32 v4, 4, v3
  ds_write_b128 v4, v[202:205] offset:33280
  ds_write_b128 v4, v[206:209] offset:37888
  s_waitcnt vmcnt(4)
  v_subrev_u32 v3, 256, v0
  v_lshlrev_b32 v4, 4, v3
  ds_write_b128 v4, v[170:173] offset:32
  ds_write_b128 v4, v[174:177] offset:4192
  ds_write_b128 v4, v[178:181] offset:8352
  ds_write_b128 v4, v[182:185] offset:12512
  ds_write_b128 v4, v[186:189] offset:16672
  ds_write_b128 v4, v[190:193] offset:20832
  ds_write_b128 v4, v[194:197] offset:24992
  ds_write_b128 v4, v[198:201] offset:29152
  v_mov_b32 v12, 0
  v_mov_b32 v13, 0
  v_mov_b32 v14, 0
  v_mov_b32 v15, 0
  v_cmp_gt_u32 vcc, 32, v3
  s_and_saveexec_b64 s[66:67], vcc
  ds_write_b128 v4, v[12:15] offset:37376
  ds_write_b128 v4, v[12:15] offset:41984
  s_mov_b64 exec, s[66:67]
  v_cmp_eq_u32 vcc, 0, v3
  s_and_saveexec_b64 s[66:67], vcc
  ds_write_b128 v4, v[12:15] offset:0
  ds_write_b128 v4, v[12:15] offset:4160
  ds_write_b128 v4, v[12:15] offset:8320
  ds_write_b128 v4, v[12:15] offset:12480
  ds_write_b128 v4, v[12:15] offset:16
  v_mov_b32 v16, 0
  v_mov_b32 v17, 0
  v_mov_b32 v18, 0
  v_lshlrev_b32 v19, 16, v170
  ds_write_b128 v4, v[16:19] offset:4176
  v_mov_b32 v20, 0
  v_mov_b32 v21, 0
  v_mov_b32 v22, 0
  v_mov_b32 v23, v170
  ds_write_b128 v4, v[20:23] offset:8336
  v_mov_b32 v32, 0
  v_mov_b32 v33, 0
  v_lshlrev_b32 v34, 16, v170
  v_alignbit_b32 v35, v171, v170, 16
  ds_write_b128 v4, v[32:35] offset:12496
  s_nop 1
  ds_write_b128 v4, v[12:15] offset:16640
  ds_write_b128 v4, v[12:15] offset:20800
  ds_write_b128 v4, v[12:15] offset:24960
  ds_write_b128 v4, v[12:15] offset:29120
  ds_write_b128 v4, v[12:15] offset:16656
  v_mov_b32 v16, 0
  v_mov_b32 v17, 0
  v_mov_b32 v18, 0
  v_lshlrev_b32 v19, 16, v186
  ds_write_b128 v4, v[16:19] offset:20816
  v_mov_b32 v20, 0
  v_mov_b32 v21, 0
  v_mov_b32 v22, 0
  v_mov_b32 v23, v186
  ds_write_b128 v4, v[20:23] offset:24976
  v_mov_b32 v32, 0
  v_mov_b32 v33, 0
  v_lshlrev_b32 v34, 16, v186
  v_alignbit_b32 v35, v187, v186, 16
  ds_write_b128 v4, v[32:35] offset:29136
  s_nop 1
  s_mov_b64 exec, s[66:67]
  s_waitcnt vmcnt(1)
  v_lshlrev_b32 v240, 16, v220
  v_and_b32 v241, 0xffff0000, v220
  v_lshlrev_b32 v242, 16, v221
  v_and_b32 v243, 0xffff0000, v221
  v_lshlrev_b32 v244, 16, v222
  v_and_b32 v245, 0xffff0000, v222
  v_lshlrev_b32 v246, 16, v223
  v_and_b32 v247, 0xffff0000, v223
  v_lshlrev_b32 v232, 16, v212
  v_and_b32 v233, 0xffff0000, v212
  v_lshlrev_b32 v234, 16, v213
  v_and_b32 v235, 0xffff0000, v213
  v_lshlrev_b32 v236, 16, v214
  v_and_b32 v237, 0xffff0000, v214
  v_lshlrev_b32 v238, 16, v215
  v_and_b32 v239, 0xffff0000, v215
  v_pk_mul_f32 v[232:233], v[232:233], v[240:241]
  v_cvt_pk_bf16_f32 v248, v232, v233
  v_lshlrev_b32 v232, 16, v248
  v_and_b32 v233, 0xffff0000, v248
  v_pk_mul_f32 v[234:235], v[234:235], v[242:243]
  v_cvt_pk_bf16_f32 v248, v234, v235
  v_lshlrev_b32 v234, 16, v248
  v_and_b32 v235, 0xffff0000, v248
  v_pk_mul_f32 v[236:237], v[236:237], v[244:245]
  v_cvt_pk_bf16_f32 v248, v236, v237
  v_lshlrev_b32 v236, 16, v248
  v_and_b32 v237, 0xffff0000, v248
  v_pk_mul_f32 v[238:239], v[238:239], v[246:247]
  v_cvt_pk_bf16_f32 v248, v238, v239
  v_lshlrev_b32 v238, 16, v248
  v_and_b32 v239, 0xffff0000, v248
  v_pk_add_f32 v[232:233], v[232:233], v[234:235]
  v_pk_add_f32 v[236:237], v[236:237], v[238:239]
  v_pk_add_f32 v[232:233], v[232:233], v[236:237]
  v_add_f32 v232, v232, v233
  s_nop 1
  v_add_f32_dpp v232, v232, v232 row_shr:1 row_mask:0xf bank_mask:0xf bound_ctrl:0
  s_nop 1
  v_add_f32_dpp v232, v232, v232 row_shr:2 row_mask:0xf bank_mask:0xf bound_ctrl:0
  s_nop 1
  v_add_f32_dpp v232, v232, v232 row_shr:4 row_mask:0xf bank_mask:0xf bound_ctrl:0
  s_nop 1
  v_add_f32_dpp v232, v232, v232 row_shr:8 row_mask:0xf bank_mask:0xf bound_ctrl:0
  s_nop 1
  v_add_f32_dpp v232, v232, v232 row_bcast:15 row_mask:0xa bank_mask:0xf
  s_nop 1
  v_add_f32_dpp v232, v232, v232 row_bcast:31 row_mask:0xc bank_mask:0xf
  s_nop 1
  v_readlane_b32 s66, v232, 63
  s_nop 1
  v_mov_b32 v232, s66
  v_cvt_pk_bf16_f32 v233, v232, v232
  v_lshlrev_b32 v232, 16, v233
  v_mul_f32 v232, 0xbfb8aa3b, v232
  v_exp_f32 v232, v232
  s_nop 0
  v_add_f32 v232, 1.0, v232
  v_rcp_f32 v232, v232
  s_nop 0
  v_cvt_pk_bf16_f32 v233, v232, v232
  v_lshlrev_b32 v224, 16, v233
  v_lshlrev_b32 v232, 16, v216
  v_and_b32 v233, 0xffff0000, v216
  v_lshlrev_b32 v234, 16, v217
  v_and_b32 v235, 0xffff0000, v217
  v_lshlrev_b32 v236, 16, v218
  v_and_b32 v237, 0xffff0000, v218
  v_lshlrev_b32 v238, 16, v219
  v_and_b32 v239, 0xffff0000, v219
  v_pk_mul_f32 v[232:233], v[232:233], v[240:241]
  v_cvt_pk_bf16_f32 v248, v232, v233
  v_lshlrev_b32 v232, 16, v248
  v_and_b32 v233, 0xffff0000, v248
  v_pk_mul_f32 v[234:235], v[234:235], v[242:243]
  v_cvt_pk_bf16_f32 v248, v234, v235
  v_lshlrev_b32 v234, 16, v248
  v_and_b32 v235, 0xffff0000, v248
  v_pk_mul_f32 v[236:237], v[236:237], v[244:245]
  v_cvt_pk_bf16_f32 v248, v236, v237
  v_lshlrev_b32 v236, 16, v248
  v_and_b32 v237, 0xffff0000, v248
  v_pk_mul_f32 v[238:239], v[238:239], v[246:247]
  v_cvt_pk_bf16_f32 v248, v238, v239
  v_lshlrev_b32 v238, 16, v248
  v_and_b32 v239, 0xffff0000, v248
  v_pk_add_f32 v[232:233], v[232:233], v[234:235]
  v_pk_add_f32 v[236:237], v[236:237], v[238:239]
  v_pk_add_f32 v[232:233], v[232:233], v[236:237]
  v_add_f32 v232, v232, v233
  s_nop 1
  v_add_f32_dpp v232, v232, v232 row_shr:1 row_mask:0xf bank_mask:0xf bound_ctrl:0
  s_nop 1
  v_add_f32_dpp v232, v232, v232 row_shr:2 row_mask:0xf bank_mask:0xf bound_ctrl:0
  s_nop 1
  v_add_f32_dpp v232, v232, v232 row_shr:4 row_mask:0xf bank_mask:0xf bound_ctrl:0
  s_nop 1
  v_add_f32_dpp v232, v232, v232 row_shr:8 row_mask:0xf bank_mask:0xf bound_ctrl:0
  s_nop 1
  v_add_f32_dpp v232, v232, v232 row_bcast:15 row_mask:0xa bank_mask:0xf
  s_nop 1
  v_add_f32_dpp v232, v232, v232 row_bcast:31 row_mask:0xc bank_mask:0xf
  s_nop 1
  v_readlane_b32 s66, v232, 63
  s_nop 1
  v_mov_b32 v232, s66
  v_cvt_pk_bf16_f32 v233, v232, v232
  v_lshlrev_b32 v232, 16, v233
  v_mul_f32 v232, 0xbfb8aa3b, v232
  v_exp_f32 v232, v232
  s_nop 0
  v_add_f32 v232, 1.0, v232
  v_rcp_f32 v232, v232
  s_nop 0
  v_cvt_pk_bf16_f32 v233, v232, v232
  v_lshlrev_b32 v225, 16, v233
  s_lshl_b32 s66, s71, 2
  s_add_u32 s66, s66, 16384
  v_mov_b32 v9, 0
  s_mov_b64 exec, 1
  buffer_store_dwordx2 v[224:225], v9, s[4:7], s66 offen sc1
  s_mov_b64 exec, -1
  s_waitcnt lgkmcnt(0)
  s_barrier
  v_lshrrev_b32 v2, 3, v1
  v_and_b32 v3, 7, v1
  v_bfe_u32 v4, v1, 4, 1
  v_lshlrev_b32 v4, 2, v4
  v_xor_b32 v3, v3, v4
  v_lshlrev_b32 v3, 4, v3
  v_lshl_add_u32 v10, v2, 10, v3
  s_and_b32 s80, s63, 7
  s_lshl_b32 s80, s80, 7
  s_sub_u32 s81, s60, 4
  s_lshl_b32 s81, s81, 1
  s_add_u32 s81, s81, 0
  s_mul_i32 s82, s81, 229376
  s_add_u32 s82, s82, s80
  s_lshl_b32 s83, s81, 13
  s_add_u32 s83, s83, 90368
  s_add_u32 m0, s83, 0
  s_add_u32 s66, s82, 0
  buffer_load_dwordx4 v10, s[20:23], s66 offen lds
  s_add_u32 m0, s83, 1024
  s_add_u32 s66, s82, 8192
  buffer_load_dwordx4 v10, s[20:23], s66 offen lds
  s_add_u32 m0, s83, 2048
  s_add_u32 s66, s82, 16384
  buffer_load_dwordx4 v10, s[20:23], s66 offen lds
  s_add_u32 m0, s83, 3072
  s_add_u32 s66, s82, 24576
  buffer_load_dwordx4 v10, s[20:23], s66 offen lds
  s_add_u32 m0, s83, 4096
  s_add_u32 s66, s82, 32768
  buffer_load_dwordx4 v10, s[20:23], s66 offen lds
  s_add_u32 m0, s83, 5120
  s_add_u32 s66, s82, 40960
  buffer_load_dwordx4 v10, s[20:23], s66 offen lds
  s_add_u32 m0, s83, 6144
  s_add_u32 s66, s82, 49152
  buffer_load_dwordx4 v10, s[20:23], s66 offen lds
  s_add_u32 m0, s83, 7168
  s_add_u32 s66, s82, 57344
  buffer_load_dwordx4 v10, s[20:23], s66 offen lds
  s_and_b32 s80, s63, 7
  s_lshl_b32 s80, s80, 7
  s_sub_u32 s81, s60, 4
  s_lshl_b32 s81, s81, 1
  s_add_u32 s81, s81, 1
  s_mul_i32 s82, s81, 229376
  s_add_u32 s82, s82, s80
  s_lshl_b32 s83, s81, 13
  s_add_u32 s83, s83, 90368
  s_add_u32 m0, s83, 0
  s_add_u32 s66, s82, 0
  buffer_load_dwordx4 v10, s[20:23], s66 offen lds
  s_add_u32 m0, s83, 1024
  s_add_u32 s66, s82, 8192
  buffer_load_dwordx4 v10, s[20:23], s66 offen lds
  s_add_u32 m0, s83, 2048
  s_add_u32 s66, s82, 16384
  buffer_load_dwordx4 v10, s[20:23], s66 offen lds
  s_add_u32 m0, s83, 3072
  s_add_u32 s66, s82, 24576
  buffer_load_dwordx4 v10, s[20:23], s66 offen lds
  s_add_u32 m0, s83, 4096
  s_add_u32 s66, s82, 32768
  buffer_load_dwordx4 v10, s[20:23], s66 offen lds
  s_add_u32 m0, s83, 5120
  s_add_u32 s66, s82, 40960
  buffer_load_dwordx4 v10, s[20:23], s66 offen lds
  s_add_u32 m0, s83, 6144
  s_add_u32 s66, s82, 49152
  buffer_load_dwordx4 v10, s[20:23], s66 offen lds
  s_add_u32 m0, s83, 7168
  s_add_u32 s66, s82, 57344
  buffer_load_dwordx4 v10, s[20:23], s66 offen lds
  s_waitcnt vmcnt(16)
L_RED:
  s_barrier
  s_cmp_eq_u32 s60, 0
  s_cbranch_scc0 FL_10
  s_lshl_b32 s66, s64, 7
  s_lshl_b32 s67, s65, 2
  s_add_u32 s66, s66, s67
  s_add_u32 s66, s66, 4096
  v_mov_b32 v2, s61
  v_mov_b32 v9, 0
  s_mov_b64 exec, 1
  buffer_store_dword v2, v9, s[4:7], s66 offen sc1
  s_mov_b64 exec, -1
FL_10:
  s_and_b32 s80, s63, 7
  s_lshl_b32 s80, s80, 7
  s_mul_i32 s72, s60, 229376
  s_add_u32 s72, s72, s80
  s_lshl_b32 s73, s60, 12
  s_lshl_b32 s76, s60, 13
  s_add_u32 s76, s76, 90368
  v_lshrrev_b32 v2, 3, v1
  v_and_b32 v3, 7, v1
  v_bfe_u32 v4, v1, 4, 1
  v_lshlrev_b32 v4, 2, v4
  v_xor_b32 v3, v3, v4
  v_lshlrev_b32 v3, 4, v3
  v_lshl_add_u32 v10, v2, 10, v3
  s_add_u32 m0, s73, 0
  s_add_u32 s66, s72, 65536
  buffer_load_dwordx4 v10, s[20:23], s66 offen lds
  s_add_u32 m0, s73, 1024
  s_add_u32 s66, s72, 73728
  buffer_load_dwordx4 v10, s[20:23], s66 offen lds
  s_add_u32 m0, s73, 2048
  s_add_u32 s66, s72, 81920
  buffer_load_dwordx4 v10, s[20:23], s66 offen lds
  s_add_u32 m0, s73, 3072
  s_add_u32 s66, s72, 90112
  buffer_load_dwordx4 v10, s[20:23], s66 offen lds
  s_lshl_b32 s66, s60, 10
  s_add_u32 s66, s66, 42496
  v_lshlrev_b32 v8, 4, v1
  v_add_u32 v8, s66, v8
  ds_read_b128 v[64:67], v8 offset:0
  ds_read_b128 v[68:71], v8 offset:8192
  ds_read_b128 v[80:83], v8 offset:16384
  ds_read_b128 v[84:87], v8 offset:24576
  v_and_b32 v2, 15, v1
  v_lshrrev_b32 v3, 4, v1
  v_lshlrev_b32 v4, 4, v2
  v_lshl_add_u32 v4, v3, 2, v4
  s_lshl_b32 s66, s60, 8
  v_add_u32 v4, s66, v4
  v_sub_u32 v5, 2044, v4
  v_lshlrev_b32 v5, 1, v5
  ds_read_b64 v[40:41], v5 offset:33280
  ds_read_b64 v[42:43], v5 offset:37888
  v_lshlrev_b32 v44, 16, v250
  v_and_b32 v45, 0xffff0000, v250
  s_waitcnt lgkmcnt(0)
  v_pk_add_f32 v[64:65], v[64:65], v[68:69]
  v_pk_add_f32 v[66:67], v[66:67], v[70:71]
  v_cvt_pk_bf16_f32 v46, v64, v65
  v_lshlrev_b32 v64, 16, v46
  v_and_b32 v65, 0xffff0000, v46
  v_cvt_pk_bf16_f32 v46, v66, v67
  v_lshlrev_b32 v66, 16, v46
  v_and_b32 v67, 0xffff0000, v46
  v_and_b32 v48, 0xffff0000, v41
  v_lshlrev_b32 v49, 16, v41
  v_and_b32 v50, 0xffff0000, v40
  v_lshlrev_b32 v51, 16, v40
  v_mul_f32 v48, v48, v44
  v_mul_f32 v49, v49, v44
  v_mul_f32 v50, v50, v44
  v_mul_f32 v51, v51, v44
  v_cvt_pk_bf16_f32 v46, v48, v49
  v_lshlrev_b32 v48, 16, v46
  v_and_b32 v49, 0xffff0000, v46
  v_cvt_pk_bf16_f32 v46, v50, v51
  v_lshlrev_b32 v50, 16, v46
  v_and_b32 v51, 0xffff0000, v46
  v_pk_add_f32 v[64:65], v[64:65], v[48:49]
  v_pk_add_f32 v[66:67], v[66:67], v[50:51]
  v_pk_add_f32 v[80:81], v[80:81], v[84:85]
  v_pk_add_f32 v[82:83], v[82:83], v[86:87]
  v_cvt_pk_bf16_f32 v46, v80, v81
  v_lshlrev_b32 v80, 16, v46
  v_and_b32 v81, 0xffff0000, v46
  v_cvt_pk_bf16_f32 v46, v82, v83
  v_lshlrev_b32 v82, 16, v46
  v_and_b32 v83, 0xffff0000, v46
  v_and_b32 v48, 0xffff0000, v43
  v_lshlrev_b32 v49, 16, v43
  v_and_b32 v50, 0xffff0000, v42
  v_lshlrev_b32 v51, 16, v42
  v_mul_f32 v48, v48, v45
  v_mul_f32 v49, v49, v45
  v_mul_f32 v50, v50, v45
  v_mul_f32 v51, v51, v45
  v_cvt_pk_bf16_f32 v46, v48, v49
  v_lshlrev_b32 v48, 16, v46
  v_and_b32 v49, 0xffff0000, v46
  v_cvt_pk_bf16_f32 v46, v50, v51
  v_lshlrev_b32 v50, 16, v46
  v_and_b32 v51, 0xffff0000, v46
  v_pk_add_f32 v[80:81], v[80:81], v[48:49]
  v_pk_add_f32 v[82:83], v[82:83], v[50:51]
  v_cvt_pk_bf16_f32 v52, v64, v80
  v_cvt_pk_bf16_f32 v53, v65, v81
  v_cvt_pk_bf16_f32 v54, v66, v82
  v_cvt_pk_bf16_f32 v55, v67, v83
  s_lshr_b32 s66, s2, 5
  s_lshl_b32 s66, s66, 18
  s_and_b32 s67, s2, 31
  s_lshl_b32 s67, s67, 8
  s_add_u32 s66, s66, s67
  s_lshl_b32 s67, s60, 15
  s_add_u32 s66, s66, s67
  s_add_u32 s66, s66, 9502720
  v_lshrrev_b32 v4, 2, v2
  v_lshlrev_b32 v4, 13, v4
  v_and_b32 v5, 3, v2
  v_lshl_add_u32 v4, v5, 6, v4
  v_lshl_add_u32 v4, v3, 4, v4
  buffer_store_dwordx4 v[52:55], v4, s[4:7], s66 offen sc1
  s_lshl_b32 s64, s62, 2
  s_lshr_b32 s65, s63, 3
  s_add_u32 s64, s64, s65
  s_and_b32 s65, s63, 7
  s_waitcnt vmcnt(0)
  s_barrier
  s_cmp_eq_u32 s60, 0
  s_cbranch_scc0 FL_11
  s_lshl_b32 s66, s2, 2
  s_add_u32 s66, s66, 8192
  v_mov_b32 v2, s61
  v_mov_b32 v9, 0
  s_mov_b64 exec, 1
  buffer_store_dword v2, v9, s[4:7], s66 offen sc1
  s_mov_b64 exec, -1
FL_11:
  s_lshr_b32 s66, s64, 1
  s_lshl_b32 s66, s66, 7
  s_add_u32 s66, s66, 4096
  v_and_b32 v5, 15, v1
  v_lshlrev_b32 v5, 2, v5
  v_add_u32 v5, s66, v5
  s_mov_b32 s95, 0x40000
POLL_12:
  buffer_load_dword v6, v5, s[4:7], 0 offen sc1
  s_waitcnt vmcnt(0)
  v_cmp_ne_u32 vcc, s61, v6
  s_cbranch_vccz POLLD_13
  s_sub_u32 s95, s95, 1
  s_cmp_eq_u32 s95, 0
  s_cbranch_scc1 POLLD_13
  s_branch POLL_12
POLLD_13:
  s_mul_i32 s74, s64, 229376
  s_mul_i32 s66, s60, 14336
  s_add_u32 s74, s74, s66
  s_add_u32 s74, s74, 2162688
  s_add_u32 s75, s74, 114688
  v_lshlrev_b32 v13, 4, v1
  buffer_load_dwordx4 v[96:99], v13, s[4:7], s74 offen offset:0 sc1
  buffer_load_dwordx4 v[100:103], v13, s[4:7], s75 offen offset:0 sc1
  buffer_load_dwordx4 v[104:107], v13, s[4:7], s74 offen offset:1024 sc1
  buffer_load_dwordx4 v[108:111], v13, s[4:7], s75 offen offset:1024 sc1
  buffer_load_dwordx4 v[112:115], v13, s[4:7], s74 offen offset:2048 sc1
  buffer_load_dwordx4 v[116:119], v13, s[4:7], s75 offen offset:2048 sc1
  buffer_load_dwordx4 v[120:123], v13, s[4:7], s74 offen offset:3072 sc1
  buffer_load_dwordx4 v[124:127], v13, s[4:7], s75 offen offset:3072 sc1
  s_and_b32 s80, s63, 7
  s_lshl_b32 s80, s80, 7
  s_mul_i32 s72, s60, 229376
  s_add_u32 s72, s72, s80
  s_lshl_b32 s73, s60, 12
  s_lshl_b32 s76, s60, 13
  s_add_u32 s76, s76, 90368
  v_lshrrev_b32 v2, 3, v1
  v_and_b32 v3, 7, v1
  v_bfe_u32 v4, v1, 4, 1
  v_lshlrev_b32 v4, 2, v4
  v_xor_b32 v3, v3, v4
  v_lshlrev_b32 v3, 4, v3
  v_lshl_add_u32 v10, v2, 10, v3
  v_and_b32 v2, 15, v1
  v_lshrrev_b32 v3, 2, v2
  v_lshrrev_b32 v4, 5, v1
  v_lshl_add_u32 v3, v4, 2, v3
  v_lshlrev_b32 v3, 7, v3
  v_bfe_u32 v4, v1, 4, 1
  v_lshlrev_b32 v4, 5, v4
  v_and_b32 v5, 3, v1
  v_lshl_add_u32 v4, v5, 3, v4
  v_bfe_u32 v5, v1, 3, 1
  v_lshlrev_b32 v5, 6, v5
  v_xor_b32 v11, v4, v5
  v_xor_b32 v12, 64, v11
  v_add_u32 v11, v11, v3
  v_add_u32 v12, v12, v3
  v_add_u32 v14, s76, v11
  v_add_u32 v15, s76, v12
  v_add_u32 v11, s73, v11
  v_add_u32 v12, s73, v12
  ds_read_b64_tr_b16 v[224:225], v14 offset:0
  ds_read_b64_tr_b16 v[226:227], v14 offset:1024
  ds_read_b64_tr_b16 v[228:229], v15 offset:0
  ds_read_b64_tr_b16 v[230:231], v15 offset:1024
  ds_read_b64_tr_b16 v[232:233], v14 offset:2048
  ds_read_b64_tr_b16 v[234:235], v14 offset:3072
  ds_read_b64_tr_b16 v[236:237], v15 offset:2048
  ds_read_b64_tr_b16 v[238:239], v15 offset:3072
  ds_read_b64_tr_b16 v[240:241], v14 offset:4096
  ds_read_b64_tr_b16 v[242:243], v14 offset:5120
  ds_read_b64_tr_b16 v[244:245], v15 offset:4096
  ds_read_b64_tr_b16 v[246:247], v15 offset:5120
  ds_read_b64_tr_b16 v[248:249], v14 offset:6144
  ds_read_b64_tr_b16 v[250:251], v14 offset:7168
  ds_read_b64_tr_b16 v[252:253], v15 offset:6144
  ds_read_b64_tr_b16 v[254:255], v15 offset:7168
  s_add_u32 m0, s73, 32768
  s_add_u32 s66, s72, 98304
  buffer_load_dwordx4 v10, s[20:23], s66 offen lds
  s_add_u32 m0, s73, 33792
  s_add_u32 s66, s72, 106496
  buffer_load_dwordx4 v10, s[20:23], s66 offen lds
  s_add_u32 m0, s73, 34816
  s_add_u32 s66, s72, 114688
  buffer_load_dwordx4 v10, s[20:23], s66 offen lds
  s_add_u32 m0, s73, 35840
  s_add_u32 s66, s72, 122880
  buffer_load_dwordx4 v10, s[20:23], s66 offen lds
  s_add_u32 s74, s74, 4096
  s_add_u32 s75, s75, 4096
  buffer_load_dwordx4 v[128:131], v13, s[4:7], s74 offen offset:0 sc1
  buffer_load_dwordx4 v[132:135], v13, s[4:7], s75 offen offset:0 sc1
  buffer_load_dwordx4 v[136:139], v13, s[4:7], s74 offen offset:1024 sc1
  buffer_load_dwordx4 v[140:143], v13, s[4:7], s75 offen offset:1024 sc1
  buffer_load_dwordx4 v[144:147], v13, s[4:7], s74 offen offset:2048 sc1
  buffer_load_dwordx4 v[148:151], v13, s[4:7], s75 offen offset:2048 sc1
  s_waitcnt lgkmcnt(0)
  s_add_u32 m0, s76, 0
  s_add_u32 s66, s72, 131072
  buffer_load_dwordx4 v10, s[20:23], s66 offen lds
  s_add_u32 m0, s76, 1024
  s_add_u32 s66, s72, 139264
  buffer_load_dwordx4 v10, s[20:23], s66 offen lds
  s_add_u32 m0, s76, 2048
  s_add_u32 s66, s72, 147456
  buffer_load_dwordx4 v10, s[20:23], s66 offen lds
  s_add_u32 m0, s76, 3072
  s_add_u32 s66, s72, 155648
  buffer_load_dwordx4 v10, s[20:23], s66 offen lds
  s_add_u32 m0, s76, 4096
  s_add_u32 s66, s72, 163840
  buffer_load_dwordx4 v10, s[20:23], s66 offen lds
  s_add_u32 m0, s76, 5120
  s_add_u32 s66, s72, 172032
  buffer_load_dwordx4 v10, s[20:23], s66 offen lds
  s_add_u32 m0, s76, 6144
  s_add_u32 s66, s72, 180224
  buffer_load_dwordx4 v10, s[20:23], s66 offen lds
  s_add_u32 m0, s76, 7168
  s_add_u32 s66, s72, 188416
  buffer_load_dwordx4 v10, s[20:23], s66 offen lds
  s_waitcnt vmcnt(24)
  v_mfma_f32_32x32x16_bf16 v[32:47], v[224:227], v[96:99], 0
  v_mfma_f32_32x32x16_bf16 v[48:63], v[224:227], v[100:103], 0
  v_mfma_f32_32x32x16_bf16 v[64:79], v[228:231], v[96:99], 0
  v_mfma_f32_32x32x16_bf16 v[80:95], v[228:231], v[100:103], 0
  buffer_load_dwordx4 v[152:155], v13, s[4:7], s74 offen offset:3072 sc1
  buffer_load_dwordx4 v[156:159], v13, s[4:7], s75 offen offset:3072 sc1
  s_waitcnt vmcnt(24)
  v_mfma_f32_32x32x16_bf16 v[32:47], v[232:235], v[104:107], v[32:47]
  v_mfma_f32_32x32x16_bf16 v[48:63], v[232:235], v[108:111], v[48:63]
  v_mfma_f32_32x32x16_bf16 v[64:79], v[236:239], v[104:107], v[64:79]
  v_mfma_f32_32x32x16_bf16 v[80:95], v[236:239], v[108:111], v[80:95]
  s_add_u32 s74, s74, 4096
  s_add_u32 s75, s75, 4096
  buffer_load_dwordx4 v[160:163], v13, s[4:7], s74 offen offset:0 sc1
  buffer_load_dwordx4 v[164:167], v13, s[4:7], s75 offen offset:0 sc1
  s_waitcnt vmcnt(24)
  v_mfma_f32_32x32x16_bf16 v[32:47], v[240:243], v[112:115], v[32:47]
  v_mfma_f32_32x32x16_bf16 v[48:63], v[240:243], v[116:119], v[48:63]
  v_mfma_f32_32x32x16_bf16 v[64:79], v[244:247], v[112:115], v[64:79]
  v_mfma_f32_32x32x16_bf16 v[80:95], v[244:247], v[116:119], v[80:95]
  buffer_load_dwordx4 v[168:171], v13, s[4:7], s74 offen offset:1024 sc1
  buffer_load_dwordx4 v[172:175], v13, s[4:7], s75 offen offset:1024 sc1
  s_waitcnt vmcnt(24)
  v_mfma_f32_32x32x16_bf16 v[32:47], v[248:251], v[120:123], v[32:47]
  ds_read_b64_tr_b16 v[208:209], v11 offset:0
  ds_read_b64_tr_b16 v[210:211], v11 offset:1024
  v_mfma_f32_32x32x16_bf16 v[48:63], v[248:251], v[124:127], v[48:63]
  ds_read_b64_tr_b16 v[212:213], v12 offset:0
  ds_read_b64_tr_b16 v[214:215], v12 offset:1024
  v_mfma_f32_32x32x16_bf16 v[64:79], v[252:255], v[120:123], v[64:79]
  v_mfma_f32_32x32x16_bf16 v[80:95], v[252:255], v[124:127], v[80:95]
  buffer_load_dwordx4 v[176:179], v13, s[4:7], s74 offen offset:2048 sc1
  buffer_load_dwordx4 v[180:183], v13, s[4:7], s75 offen offset:2048 sc1
  s_waitcnt lgkmcnt(0)
  s_waitcnt vmcnt(20)
  v_mfma_f32_32x32x16_bf16 v[32:47], v[208:211], v[128:131], v[32:47]
  ds_read_b64_tr_b16 v[216:217], v11 offset:2048
  ds_read_b64_tr_b16 v[218:219], v11 offset:3072
  v_mfma_f32_32x32x16_bf16 v[48:63], v[208:211], v[132:135], v[48:63]
  ds_read_b64_tr_b16 v[220:221], v12 offset:2048
  ds_read_b64_tr_b16 v[222:223], v12 offset:3072
  v_mfma_f32_32x32x16_bf16 v[64:79], v[212:215], v[128:131], v[64:79]
  v_mfma_f32_32x32x16_bf16 v[80:95], v[212:215], v[132:135], v[80:95]
  buffer_load_dwordx4 v[184:187], v13, s[4:7], s74 offen offset:3072 sc1
  buffer_load_dwordx4 v[188:191], v13, s[4:7], s75 offen offset:3072 sc1
  s_waitcnt lgkmcnt(0)
  s_waitcnt vmcnt(20)
  v_mfma_f32_32x32x16_bf16 v[32:47], v[216:219], v[136:139], v[32:47]
  ds_read_b64_tr_b16 v[208:209], v11 offset:32768
  ds_read_b64_tr_b16 v[210:211], v11 offset:33792
  v_mfma_f32_32x32x16_bf16 v[48:63], v[216:219], v[140:143], v[48:63]
  ds_read_b64_tr_b16 v[212:213], v12 offset:32768
  ds_read_b64_tr_b16 v[214:215], v12 offset:33792
  v_mfma_f32_32x32x16_bf16 v[64:79], v[220:223], v[136:139], v[64:79]
  v_mfma_f32_32x32x16_bf16 v[80:95], v[220:223], v[140:143], v[80:95]
  s_add_u32 s74, s74, 4096
  s_add_u32 s75, s75, 4096
  buffer_load_dwordx4 v[192:195], v13, s[4:7], s74 offen offset:0 sc1
  buffer_load_dwordx4 v[196:199], v13, s[4:7], s75 offen offset:0 sc1
  s_add_u32 m0, s73, 0
  s_add_u32 s66, s72, 196608
  buffer_load_dwordx4 v10, s[20:23], s66 offen lds
  s_add_u32 m0, s73, 1024
  s_add_u32 s66, s72, 204800
  buffer_load_dwordx4 v10, s[20:23], s66 offen lds
  s_add_u32 m0, s73, 2048
  s_add_u32 s66, s72, 212992
  buffer_load_dwordx4 v10, s[20:23], s66 offen lds
  s_add_u32 m0, s73, 3072
  s_add_u32 s66, s72, 221184
  buffer_load_dwordx4 v10, s[20:23], s66 offen lds
  s_waitcnt lgkmcnt(0)
  s_waitcnt vmcnt(24)
  v_mfma_f32_32x32x16_bf16 v[32:47], v[208:211], v[144:147], v[32:47]
  ds_read_b64_tr_b16 v[216:217], v11 offset:34816
  ds_read_b64_tr_b16 v[218:219], v11 offset:35840
  v_mfma_f32_32x32x16_bf16 v[48:63], v[208:211], v[148:151], v[48:63]
  ds_read_b64_tr_b16 v[220:221], v12 offset:34816
  ds_read_b64_tr_b16 v[222:223], v12 offset:35840
  v_mfma_f32_32x32x16_bf16 v[64:79], v[212:215], v[144:147], v[64:79]
  v_mfma_f32_32x32x16_bf16 v[80:95], v[212:215], v[148:151], v[80:95]
  buffer_load_dwordx4 v[200:203], v13, s[4:7], s74 offen offset:1024 sc1
  buffer_load_dwordx4 v[204:207], v13, s[4:7], s75 offen offset:1024 sc1
  v_lshrrev_b32 v3, 3, v0
  v_and_b32 v4, 7, v0
  s_lshl_b32 s66, s64, 16
  s_lshl_b32 s67, s65, 7
  s_add_u32 s77, s66, s67
  v_lshlrev_b32 v16, 10, v3
  v_lshl_add_u32 v16, v4, 4, v16
  s_lshl_b32 s66, s65, 18
  s_lshl_b32 s67, s64, 13
  s_add_u32 s78, s66, s67
  s_add_u32 s78, s78, 9502720
  v_lshlrev_b32 v17, 10, v4
  v_lshl_add_u32 v17, v3, 2, v17
  s_lshl_b32 s79, s64, 8
  s_add_u32 s79, s79, 16384
  v_lshlrev_b32 v18, 2, v3
  v_mul_u32_u24 v19, 272, v3
  v_lshl_add_u32 v19, v4, 5, v19
  buffer_load_dwordx4 v[20:23], v16, s[24:27], s77 offen
  buffer_load_dword v28, v18, s[4:7], s79 offen sc1
  s_waitcnt lgkmcnt(0)
  s_waitcnt vmcnt(18)
  v_mfma_f32_32x32x16_bf16 v[32:47], v[216:219], v[152:155], v[32:47]
  ds_read_b64_tr_b16 v[208:209], v14 offset:0
  ds_read_b64_tr_b16 v[210:211], v14 offset:1024
  v_mfma_f32_32x32x16_bf16 v[48:63], v[216:219], v[156:159], v[48:63]
  ds_read_b64_tr_b16 v[212:213], v15 offset:0
  ds_read_b64_tr_b16 v[214:215], v15 offset:1024
  v_mfma_f32_32x32x16_bf16 v[64:79], v[220:223], v[152:155], v[64:79]
  v_mfma_f32_32x32x16_bf16 v[80:95], v[220:223], v[156:159], v[80:95]
  s_waitcnt lgkmcnt(0)
  s_waitcnt vmcnt(16)
  v_mfma_f32_32x32x16_bf16 v[32:47], v[208:211], v[160:163], v[32:47]
  ds_read_b64_tr_b16 v[216:217], v14 offset:2048
  ds_read_b64_tr_b16 v[218:219], v14 offset:3072
  v_mfma_f32_32x32x16_bf16 v[48:63], v[208:211], v[164:167], v[48:63]
  ds_read_b64_tr_b16 v[220:221], v15 offset:2048
  ds_read_b64_tr_b16 v[222:223], v15 offset:3072
  v_mfma_f32_32x32x16_bf16 v[64:79], v[212:215], v[160:163], v[64:79]
  v_mfma_f32_32x32x16_bf16 v[80:95], v[212:215], v[164:167], v[80:95]
  s_waitcnt lgkmcnt(0)
  s_waitcnt vmcnt(14)
  v_mfma_f32_32x32x16_bf16 v[32:47], v[216:219], v[168:171], v[32:47]
  ds_read_b64_tr_b16 v[208:209], v14 offset:4096
  ds_read_b64_tr_b16 v[210:211], v14 offset:5120
  v_mfma_f32_32x32x16_bf16 v[48:63], v[216:219], v[172:175], v[48:63]
  ds_read_b64_tr_b16 v[212:213], v15 offset:4096
  ds_read_b64_tr_b16 v[214:215], v15 offset:5120
  v_mfma_f32_32x32x16_bf16 v[64:79], v[220:223], v[168:171], v[64:79]
  v_mfma_f32_32x32x16_bf16 v[80:95], v[220:223], v[172:175], v[80:95]
  s_waitcnt lgkmcnt(0)
  s_waitcnt vmcnt(12)
  v_mfma_f32_32x32x16_bf16 v[32:47], v[208:211], v[176:179], v[32:47]
  ds_read_b64_tr_b16 v[216:217], v14 offset:6144
  ds_read_b64_tr_b16 v[218:219], v14 offset:7168
  v_mfma_f32_32x32x16_bf16 v[48:63], v[208:211], v[180:183], v[48:63]
  ds_read_b64_tr_b16 v[220:221], v15 offset:6144
  ds_read_b64_tr_b16 v[222:223], v15 offset:7168
  v_mfma_f32_32x32x16_bf16 v[64:79], v[212:215], v[176:179], v[64:79]
  v_mfma_f32_32x32x16_bf16 v[80:95], v[212:215], v[180:183], v[80:95]
  s_lshl_b32 s66, s65, 7
  s_add_u32 s66, s66, 8192
  v_and_b32 v30, 31, v1
  v_lshlrev_b32 v30, 2, v30
  v_add_u32 v30, s66, v30
  buffer_load_dword v29, v30, s[4:7], 0 offen sc1
  s_waitcnt lgkmcnt(0)
  s_waitcnt vmcnt(11)
  s_waitcnt vmcnt(5)
  v_mfma_f32_32x32x16_bf16 v[32:47], v[216:219], v[184:187], v[32:47]
  ds_read_b64_tr_b16 v[208:209], v11 offset:0
  ds_read_b64_tr_b16 v[210:211], v11 offset:1024
  v_mfma_f32_32x32x16_bf16 v[48:63], v[216:219], v[188:191], v[48:63]
  ds_read_b64_tr_b16 v[212:213], v12 offset:0
  ds_read_b64_tr_b16 v[214:215], v12 offset:1024
  v_mfma_f32_32x32x16_bf16 v[64:79], v[220:223], v[184:187], v[64:79]
  v_mfma_f32_32x32x16_bf16 v[80:95], v[220:223], v[188:191], v[80:95]
  s_waitcnt lgkmcnt(0)
  v_mfma_f32_32x32x16_bf16 v[32:47], v[208:211], v[192:195], v[32:47]
  ds_read_b64_tr_b16 v[216:217], v11 offset:2048
  ds_read_b64_tr_b16 v[218:219], v11 offset:3072
  v_mfma_f32_32x32x16_bf16 v[48:63], v[208:211], v[196:199], v[48:63]
  ds_read_b64_tr_b16 v[220:221], v12 offset:2048
  ds_read_b64_tr_b16 v[222:223], v12 offset:3072
  v_mfma_f32_32x32x16_bf16 v[64:79], v[212:215], v[192:195], v[64:79]
  v_mfma_f32_32x32x16_bf16 v[80:95], v[212:215], v[196:199], v[80:95]
  s_waitcnt lgkmcnt(0)
  s_waitcnt vmcnt(3)
  v_mfma_f32_32x32x16_bf16 v[32:47], v[216:219], v[200:203], v[32:47]
  v_mfma_f32_32x32x16_bf16 v[48:63], v[216:219], v[204:207], v[48:63]
  v_mfma_f32_32x32x16_bf16 v[64:79], v[220:223], v[200:203], v[64:79]
  v_mfma_f32_32x32x16_bf16 v[80:95], v[220:223], v[204:207], v[80:95]
  s_barrier
  v_and_b32 v2, 31, v1
  v_mul_u32_u24 v2, 272, v2
  v_lshrrev_b32 v3, 5, v1
  v_lshl_add_u32 v2, v3, 4, v2
  s_mul_i32 s73, s60, 17408
  v_add_u32 v2, s73, v2
  s_nop 7
  s_nop 3
  ds_write_b128 v2, v[32:35] offset:0
  ds_write_b128 v2, v[36:39] offset:32
  ds_write_b128 v2, v[40:43] offset:64
  ds_write_b128 v2, v[44:47] offset:96
  ds_write_b128 v2, v[48:51] offset:8704
  ds_write_b128 v2, v[52:55] offset:8736
  ds_write_b128 v2, v[56:59] offset:8768
  ds_write_b128 v2, v[60:63] offset:8800
  ds_write_b128 v2, v[64:67] offset:128
  ds_write_b128 v2, v[68:71] offset:160
  ds_write_b128 v2, v[72:75] offset:192
  ds_write_b128 v2, v[76:79] offset:224
  ds_write_b128 v2, v[80:83] offset:8832
  ds_write_b128 v2, v[84:87] offset:8864
  ds_write_b128 v2, v[88:91] offset:8896
  ds_write_b128 v2, v[92:95] offset:8928
  s_waitcnt lgkmcnt(0)
  s_waitcnt vmcnt(0)
  v_cmp_ne_u32 vcc, s61, v29
  s_cbranch_vccz F2OK_14
  s_mov_b32 s95, 0x40000
POLL_15:
  buffer_load_dword v29, v30, s[4:7], 0 offen sc1
  s_waitcnt vmcnt(0)
  v_cmp_ne_u32 vcc, s61, v29
  s_cbranch_vccz POLLD_16
  s_sub_u32 s95, s95, 1
  s_cmp_eq_u32 s95, 0
  s_cbranch_scc1 POLLD_16
  s_branch POLL_15
POLLD_16:
F2OK_14:
  buffer_load_dword v24, v17, s[4:7], s78 offen offset:0 sc1
  buffer_load_dword v25, v17, s[4:7], s78 offen offset:256 sc1
  buffer_load_dword v26, v17, s[4:7], s78 offen offset:512 sc1
  buffer_load_dword v27, v17, s[4:7], s78 offen offset:768 sc1
  s_barrier
  v_add_u32 v14, 0x10000, v19
  ds_read_b128 v[64:67], v19 offset:0
  ds_read_b128 v[68:71], v19 offset:16
  ds_read_b128 v[72:75], v19 offset:17408
  ds_read_b128 v[76:79], v19 offset:17424
  ds_read_b128 v[80:83], v19 offset:34816
  ds_read_b128 v[84:87], v19 offset:34832
  ds_read_b128 v[88:91], v19 offset:52224
  ds_read_b128 v[92:95], v19 offset:52240
  ds_read_b128 v[96:99], v14 offset:4096
  ds_read_b128 v[100:103], v14 offset:4112
  ds_read_b128 v[104:107], v14 offset:21504
  ds_read_b128 v[108:111], v14 offset:21520
  ds_read_b128 v[112:115], v14 offset:38912
  ds_read_b128 v[116:119], v14 offset:38928
  ds_read_b128 v[120:123], v14 offset:56320
  ds_read_b128 v[124:127], v14 offset:56336
  s_waitcnt lgkmcnt(0)
  v_pk_add_f32 v[64:65], v[64:65], v[72:73]
  v_pk_add_f32 v[80:81], v[80:81], v[88:89]
  v_pk_add_f32 v[96:97], v[96:97], v[104:105]
  v_pk_add_f32 v[112:113], v[112:113], v[120:121]
  v_pk_add_f32 v[64:65], v[64:65], v[80:81]
  v_pk_add_f32 v[96:97], v[96:97], v[112:113]
  v_pk_add_f32 v[64:65], v[64:65], v[96:97]
  v_pk_add_f32 v[66:67], v[66:67], v[74:75]
  v_pk_add_f32 v[82:83], v[82:83], v[90:91]
  v_pk_add_f32 v[98:99], v[98:99], v[106:107]
  v_pk_add_f32 v[114:115], v[114:115], v[122:123]
  v_pk_add_f32 v[66:67], v[66:67], v[82:83]
  v_pk_add_f32 v[98:99], v[98:99], v[114:115]
  v_pk_add_f32 v[66:67], v[66:67], v[98:99]
  v_pk_add_f32 v[68:69], v[68:69], v[76:77]
  v_pk_add_f32 v[84:85], v[84:85], v[92:93]
  v_pk_add_f32 v[100:101], v[100:101], v[108:109]
  v_pk_add_f32 v[116:117], v[116:117], v[124:125]
  v_pk_add_f32 v[68:69], v[68:69], v[84:85]
  v_pk_add_f32 v[100:101], v[100:101], v[116:117]
  v_pk_add_f32 v[68:69], v[68:69], v[100:101]
  v_pk_add_f32 v[70:71], v[70:71], v[78:79]
  v_pk_add_f32 v[86:87], v[86:87], v[94:95]
  v_pk_add_f32 v[102:103], v[102:103], v[110:111]
  v_pk_add_f32 v[118:119], v[118:119], v[126:127]
  v_pk_add_f32 v[70:71], v[70:71], v[86:87]
  v_pk_add_f32 v[102:103], v[102:103], v[118:119]
  v_pk_add_f32 v[70:71], v[70:71], v[102:103]
  s_waitcnt vmcnt(0)
  v_cvt_pk_bf16_f32 v130, v64, v65
  v_lshlrev_b32 v64, 16, v130
  v_and_b32 v65, 0xffff0000, v130
  v_cvt_pk_bf16_f32 v130, v66, v67
  v_lshlrev_b32 v66, 16, v130
  v_and_b32 v67, 0xffff0000, v130
  v_cvt_pk_bf16_f32 v130, v68, v69
  v_lshlrev_b32 v68, 16, v130
  v_and_b32 v69, 0xffff0000, v130
  v_cvt_pk_bf16_f32 v130, v70, v71
  v_lshlrev_b32 v70, 16, v130
  v_and_b32 v71, 0xffff0000, v130
  v_lshlrev_b32 v72, 16, v20
  v_and_b32 v73, 0xffff0000, v20
  v_lshlrev_b32 v80, 16, v24
  v_and_b32 v81, 0xffff0000, v24
  v_lshlrev_b32 v74, 16, v21
  v_and_b32 v75, 0xffff0000, v21
  v_lshlrev_b32 v82, 16, v25
  v_and_b32 v83, 0xffff0000, v25
  v_lshlrev_b32 v76, 16, v22
  v_and_b32 v77, 0xffff0000, v22
  v_lshlrev_b32 v84, 16, v26
  v_and_b32 v85, 0xffff0000, v26
  v_lshlrev_b32 v78, 16, v23
  v_and_b32 v79, 0xffff0000, v23
  v_lshlrev_b32 v86, 16, v27
  v_and_b32 v87, 0xffff0000, v27
  v_sub_f32 v131, 1.0, v28
  v_cvt_pk_bf16_f32 v130, v131, v131
  v_lshlrev_b32 v132, 16, v130
  v_lshlrev_b32 v133, 16, v130
  v_mov_b32 v134, v28
  v_mov_b32 v135, v28
  v_pk_mul_f32 v[72:73], v[72:73], v[80:81]
  v_cvt_pk_bf16_f32 v130, v72, v73
  v_lshlrev_b32 v72, 16, v130
  v_and_b32 v73, 0xffff0000, v130
  v_pk_mul_f32 v[72:73], v[72:73], v[134:135]
  v_cvt_pk_bf16_f32 v130, v72, v73
  v_lshlrev_b32 v72, 16, v130
  v_and_b32 v73, 0xffff0000, v130
  v_pk_mul_f32 v[64:65], v[64:65], v[132:133]
  v_cvt_pk_bf16_f32 v130, v64, v65
  v_lshlrev_b32 v64, 16, v130
  v_and_b32 v65, 0xffff0000, v130
  v_pk_add_f32 v[72:73], v[72:73], v[64:65]
  v_cvt_pk_bf16_f32 v88, v72, v73
  v_pk_mul_f32 v[74:75], v[74:75], v[82:83]
  v_cvt_pk_bf16_f32 v130, v74, v75
  v_lshlrev_b32 v74, 16, v130
  v_and_b32 v75, 0xffff0000, v130
  v_pk_mul_f32 v[74:75], v[74:75], v[134:135]
  v_cvt_pk_bf16_f32 v130, v74, v75
  v_lshlrev_b32 v74, 16, v130
  v_and_b32 v75, 0xffff0000, v130
  v_pk_mul_f32 v[66:67], v[66:67], v[132:133]
  v_cvt_pk_bf16_f32 v130, v66, v67
  v_lshlrev_b32 v66, 16, v130
  v_and_b32 v67, 0xffff0000, v130
  v_pk_add_f32 v[74:75], v[74:75], v[66:67]
  v_cvt_pk_bf16_f32 v89, v74, v75
  v_pk_mul_f32 v[76:77], v[76:77], v[84:85]
  v_cvt_pk_bf16_f32 v130, v76, v77
  v_lshlrev_b32 v76, 16, v130
  v_and_b32 v77, 0xffff0000, v130
  v_pk_mul_f32 v[76:77], v[76:77], v[134:135]
  v_cvt_pk_bf16_f32 v130, v76, v77
  v_lshlrev_b32 v76, 16, v130
  v_and_b32 v77, 0xffff0000, v130
  v_pk_mul_f32 v[68:69], v[68:69], v[132:133]
  v_cvt_pk_bf16_f32 v130, v68, v69
  v_lshlrev_b32 v68, 16, v130
  v_and_b32 v69, 0xffff0000, v130
  v_pk_add_f32 v[76:77], v[76:77], v[68:69]
  v_cvt_pk_bf16_f32 v90, v76, v77
  v_pk_mul_f32 v[78:79], v[78:79], v[86:87]
  v_cvt_pk_bf16_f32 v130, v78, v79
  v_lshlrev_b32 v78, 16, v130
  v_and_b32 v79, 0xffff0000, v130
  v_pk_mul_f32 v[78:79], v[78:79], v[134:135]
  v_cvt_pk_bf16_f32 v130, v78, v79
  v_lshlrev_b32 v78, 16, v130
  v_and_b32 v79, 0xffff0000, v130
  v_pk_mul_f32 v[70:71], v[70:71], v[132:133]
  v_cvt_pk_bf16_f32 v130, v70, v71
  v_lshlrev_b32 v70, 16, v130
  v_and_b32 v71, 0xffff0000, v130
  v_pk_add_f32 v[78:79], v[78:79], v[70:71]
  v_cvt_pk_bf16_f32 v91, v78, v79
  buffer_store_dwordx4 v[88:91], v16, s[28:31], s77 offen sc1
  s_cmp_eq_u32 s2, 0
  s_cbranch_scc0 L_END
  s_cmp_eq_u32 s60, 4
  s_cbranch_scc0 L_END
  v_lshlrev_b32 v5, 2, v1
  v_add_u32 v5, 0, v5
  s_mov_b32 s95, 0x40000
POLL_17:
  buffer_load_dword v6, v5, s[4:7], 0 offen sc1
  s_waitcnt vmcnt(0)
  v_cmp_ne_u32 vcc, s61, v6
  s_cbranch_vccz POLLD_18
  s_sub_u32 s95, s95, 1
  s_cmp_eq_u32 s95, 0
  s_cbranch_scc1 POLLD_18
  s_branch POLL_17
POLLD_18:
  v_lshlrev_b32 v5, 2, v1
  v_add_u32 v5, 256, v5
  s_mov_b32 s95, 0x40000
POLL_19:
  buffer_load_dword v6, v5, s[4:7], 0 offen sc1
  s_waitcnt vmcnt(0)
  v_cmp_ne_u32 vcc, s61, v6
  s_cbranch_vccz POLLD_20
  s_sub_u32 s95, s95, 1
  s_cmp_eq_u32 s95, 0
  s_cbranch_scc1 POLLD_20
  s_branch POLL_19
POLLD_20:
  v_lshlrev_b32 v5, 2, v1
  v_add_u32 v5, 512, v5
  s_mov_b32 s95, 0x40000
POLL_21:
  buffer_load_dword v6, v5, s[4:7], 0 offen sc1
  s_waitcnt vmcnt(0)
  v_cmp_ne_u32 vcc, s61, v6
  s_cbranch_vccz POLLD_22
  s_sub_u32 s95, s95, 1
  s_cmp_eq_u32 s95, 0
  s_cbranch_scc1 POLLD_22
  s_branch POLL_21
POLLD_22:
  v_lshlrev_b32 v5, 2, v1
  v_add_u32 v5, 768, v5
  s_mov_b32 s95, 0x40000
POLL_23:
  buffer_load_dword v6, v5, s[4:7], 0 offen sc1
  s_waitcnt vmcnt(0)
  v_cmp_ne_u32 vcc, s61, v6
  s_cbranch_vccz POLLD_24
  s_sub_u32 s95, s95, 1
  s_cmp_eq_u32 s95, 0
  s_cbranch_scc1 POLLD_24
  s_branch POLL_23
POLLD_24:
  v_mov_b32 v2, s61
  v_mov_b32 v9, 0
  s_mov_b32 s66, 12288
  s_mov_b64 exec, 1
  buffer_store_dword v2, v9, s[4:7], s66 offen sc1
  s_mov_b64 exec, -1
L_END:
  s_endpgm
.section .rodata,"a"
.p2align 6
.amdhsa_kernel gated_mix__ssm_conv_h3__glu_gated_geglu__prompt_kernel
  .amdhsa_next_free_vgpr 256
  .amdhsa_next_free_sgpr 102
  .amdhsa_accum_offset 256
  .amdhsa_group_segment_fixed_size 0
  .amdhsa_kernarg_size 112
  .amdhsa_user_sgpr_count 2
  .amdhsa_user_sgpr_kernarg_segment_ptr 1
  .amdhsa_system_sgpr_workgroup_id_x 1
.end_amdhsa_kernel
```
